```python
import torch

def _softmax(x, axis=-1):
    return torch.softmax(x, dim=axis)
def _gelu(x):
    return torch.nn.functional.gelu(x, approximate="tanh")
def _silu(x):
    return torch.nn.functional.silu(x)
def _sigmoid(x):
    return torch.sigmoid(x)
def _layernorm(x, axis=-1, eps=1e-5):
    m = x.mean(dim=axis, keepdim=True)
    v = x.var(dim=axis, keepdim=True, unbiased=False)
    return (x - m) / torch.sqrt(v + eps)
def _scatter_add(tgt, idx, src, axis=0):
    return tgt.clone().index_add_(axis, idx, src)
def _segment_sum(src, seg, n):
    out = torch.zeros((n,) + src.shape[1:], dtype=src.dtype)
    return out.index_add_(0, seg, src)
def _pad(x, pw):
    flat = tuple(v for pair in reversed(pw) for v in pair)
    return torch.nn.functional.pad(x, flat)

kernel_name = 'recurrent_scan__ssm_conv_s4d__moe_arch_mod__prompt'

def setup_inputs():

    _w = (lambda a: (lambda t: t.to(torch.bfloat16) if t.is_floating_point() else t)(torch.as_tensor(a)))
    def _A_setup():
        Bsz, L, D, N = 1, 2048, 512, 128
        return {
            "u": _w((lambda *s: torch.randn(*s, dtype=torch.bfloat16) * 0.05)(Bsz, L, D)),
            "log_A_real": _w((lambda *s: torch.randn(*s, dtype=torch.bfloat16) * 3.2)(D, N) * 0.5),
            "A_imag": _w((lambda *s: torch.randn(*s, dtype=torch.bfloat16) * 0.05)(D, N) * 3.14),
            "C_real": _w((lambda *s: torch.randn(*s, dtype=torch.bfloat16) * 0.1)(D, N) / N ** 0.5),
            "C_imag": _w((lambda *s: torch.randn(*s, dtype=torch.bfloat16) * 0.1)(D, N) / N ** 0.5),
            "log_dt": _w((lambda *s: torch.randn(*s, dtype=torch.bfloat16) * 0.05)(D) * 0.5 - 4.0),
            "D_skip": _w((lambda *s: torch.randn(*s, dtype=torch.bfloat16) * 0.05)(D)),
        }
    _A_in = _A_setup()

    def _B_setup():
        B, S, D, F, C = 1, 2048, 512, 1376, 1
        return {
            "x": _w((lambda *s: torch.randn(*s, dtype=torch.bfloat16) * 0.05)(B, S, D)),
            "w_r": _w((lambda *s: torch.randn(*s, dtype=torch.bfloat16) * 3.2)(D)),
            "w_gate": _w((lambda *s: torch.randn(*s, dtype=torch.bfloat16) * 0.1)(D, F)),
            "w_up": _w((lambda *s: torch.randn(*s, dtype=torch.bfloat16) * 0.1)(D, F)),
            "w_down": _w((lambda *s: torch.randn(*s, dtype=torch.bfloat16) * 0.1)(F, D)),
        }
    _B_in = _B_setup()

    return {
        "A_u": _A_in["u"],
        "A_log_A_real": _A_in["log_A_real"],
        "A_A_imag": _A_in["A_imag"],
        "A_C_real": _A_in["C_real"],
        "A_C_imag": _A_in["C_imag"],
        "A_log_dt": _A_in["log_dt"],
        "A_D_skip": _A_in["D_skip"],
        "B_x": _B_in["x"],
        "B_w_r": _B_in["w_r"],
        "B_w_gate": _B_in["w_gate"],
        "B_w_up": _B_in["w_up"],
        "B_w_down": _B_in["w_down"],
    }

def reference(A_u, A_log_A_real, A_A_imag, A_C_real, A_C_imag, A_log_dt, A_D_skip, B_x, B_w_r, B_w_gate, B_w_up, B_w_down):
    def _A_ref(u, log_A_real, A_imag, C_real, C_imag, log_dt, D_skip):
        L = u.shape[1]
        dt = torch.exp(log_dt)
        A = -torch.exp(log_A_real) + 1j * A_imag
        C = (C_real + 1j * C_imag) * dt[:, None]
        pos = (lambda x, dt: x.to(dt))(torch.arange(L), log_dt.dtype)
        P = torch.exp((A * dt[:, None])[:, :, None] * pos[None, None, :])
        K = 2.0 * torch.einsum("dn,dnl->dl", C, P).real
        L2 = 2 * L
        u_t = (lambda x, *d: x.permute(*d))(u, 0, 2, 1)
        Kf = (lambda x, *a, **k: torch.fft.rfft(x.float(), *a, **k))(K, L2)
        Uf = (lambda x, *a, **k: torch.fft.rfft(x.float(), *a, **k))(u_t, L2)
        y = (lambda x, *a, **k: torch.fft.irfft(x, *a, **k).to(torch.bfloat16))(Uf * Kf[None, :, :], L2)[:, :, :L]
        y = (lambda x, *d: x.permute(*d))(y, 0, 2, 1)
        return y + u * D_skip[None, None, :]

    def _B_ref(x, w_r, w_gate, w_up, w_down):
        B, S, D = x.shape
        C = 1
        r = x @ w_r
        idx = torch.argsort(-r, axis=-1)[:, :C]
        idx_e = (lambda x, n, axis: torch.repeat_interleave(x, n, dim=axis))(idx.reshape(B, C, 1), D, axis=2)
        x_sel = (lambda x, i, axis: torch.take_along_dim(x, i, dim=axis))(x, idx_e, axis=1)
        g = _silu(x_sel @ w_gate)
        u = x_sel @ w_up
        y = (g * u) @ w_down
        r_sel = _sigmoid((lambda x, i, axis: torch.take_along_dim(x, i, dim=axis))(r, idx, axis=1))
        y = y * r_sel.reshape(B, C, 1)
        b_off = (torch.arange(B) * S).reshape(B, 1)
        flat_idx = (idx + b_off).reshape(B * C)
        zero = (x * 0.0).reshape(B * S, D)
        upd = _scatter_add(zero, flat_idx, y.reshape(B * C, D), axis=0)
        return x + upd.reshape(B, S, D)

    x = A_u
    xn = _layernorm(x, axis=-1)
    s = _A_ref(xn, A_log_A_real, A_A_imag, A_C_real, A_C_imag, A_log_dt, A_D_skip)
    g = _silu(_B_ref(xn, B_w_r, B_w_gate, B_w_up, B_w_down))
    return x + s * g
```

```asm
; @launch grid=(256,1,1) block=(512,1,1) lds=163840
.amdgcn_target "amdgcn-amd-amdhsa--gfx950"
.text
.globl recurrent_scan__ssm_conv_s4d__moe_arch_mod__prompt_kernel
.p2align 8
.type recurrent_scan__ssm_conv_s4d__moe_arch_mod__prompt_kernel,@function
recurrent_scan__ssm_conv_s4d__moe_arch_mod__prompt_kernel:
L_BEGIN:
  s_cmp_ge_u32 s2, 0x100
  s_cbranch_scc1 L_EXIT
  s_load_dwordx16 s[4:19], s[0:1], 0
  s_load_dwordx2 s[32:33], s[0:1], 112
  s_load_dwordx8 s[20:27], s[0:1], 64
  s_load_dwordx4 s[28:31], s[0:1], 96
  s_getpc_b64 s[50:51]
L_PC:
  s_lshr_b32 s44, s2, 3
  s_and_b32 s52, s44, 7
  s_lshl_b32 s52, s52, 12
  v_and_b32 v1, 0x1f8, v0
  v_lshl_add_u32 v1, v1, 3, s52
  v_min_u32 v1, L_END-L_PC-4, v1
  global_load_dword v1, v1, s[50:51]
  v_and_b32 v18, 31, v0
  v_lshlrev_b32 v18, 4, v18
  v_mov_b32 v22, 0
  v_mov_b32 v23, 0
  v_add_u32 v20, 163136, v18
  ds_write_b64 v20, v[22:23]
  s_and_b32 s53, s2, 7
  s_lshl_b32 s45, s53, 5
  s_add_u32 s45, s45, s44
  s_lshr_b32 s42, s45, 1
  v_lshrrev_b32 v21, 5, v0
  s_lshl_b32 s54, s45, 13
  s_and_b32 s43, s44, 1
  v_lshl_add_u32 v19, v21, 10, v18
  v_add_u32 v19, s54, v19
  v_and_b32 v20, 0xff, v0
  s_lshl_b32 s55, s42, 10
  v_lshl_add_u32 v20, v20, 2, s55
  s_lshl_b32 s56, s42, 3
  v_readfirstlane_b32 s40, v21
  s_cmp_lt_u32 s40, 8
  s_waitcnt lgkmcnt(0)
  s_cbranch_scc1 L_ULD
  global_load_dword v14, v20, s[6:7]
  global_load_dword v15, v20, s[8:9]
  global_load_dword v16, v20, s[10:11]
  global_load_dword v17, v20, s[12:13]
  s_load_dwordx2 s[34:35], s[14:15], s56
  s_barrier
  s_lshr_b32 s40, s40, 1
  s_and_b32 s41, s40, 3
  v_and_b32 v24, 63, v0
  v_lshlrev_b32 v25, 2, v24
  v_lshlrev_b32 v26, 4, v24
  s_branch L_KROLE
L_ULD:
  global_load_dwordx4 v[2:5], v19, s[4:5]
  global_load_dwordx4 v[6:9], v19, s[4:5] offset:512
  s_load_dword s38, s[32:33], 0
  global_load_dwordx4 v[10:13], v18, s[20:21]
  global_load_dwordx4 v[14:17], v18, s[20:21] offset:512
  s_load_dwordx2 s[36:37], s[16:17], s56
  s_barrier
  s_lshr_b32 s40, s40, 1
  s_and_b32 s41, s40, 3
  v_and_b32 v24, 63, v0
  v_lshlrev_b32 v25, 2, v24
  v_lshlrev_b32 v26, 4, v24
  s_setprio 3
  s_lshr_b32 s50, s40, 1
  s_mul_i32 s18, s50, 3
  s_xor_b32 s18, s18, s43
  s_and_b32 s19, s40, 1
  s_lshl_b32 s51, s18, 1
  s_add_u32 s19, s19, s51
  s_lshl_b32 s51, s19, 17
  s_lshl_b32 s52, s42, 3
  s_add_u32 s51, s51, s52
  v_lshl_add_u32 v28, v24, 11, s51
  v_add_u32 v29, 0x100000, v28
  s_lshr_b32 s50, s44, 1
  s_lshr_b32 s51, s50, 2
  s_lshl_b32 s51, s51, 3
  s_and_b32 s52, s2, 7
  s_add_u32 s51, s51, s52
  s_lshl_b32 s51, s51, 2
  s_and_b32 s50, s50, 3
  s_add_u32 s47, s51, s50
  s_cmp_eq_u32 s43, 1
  s_cselect_b32 s47, s47, 127
  s_cmp_lt_u32 s47, 86
  s_cselect_b64 s[48:49], -1, 0
  s_cselect_b32 s47, s47, 0
  s_lshl_b32 s58, s47, 14
  s_lshl_b32 s59, s40, 8
  s_add_u32 s58, s58, s59
  s_add_u32 s58, s58, 4096
  v_add_u32 v48, s58, v25
  v_add_u32 v49, 0x2000, v48
  v_lshrrev_b32 v31, 1, v24
  s_lshl_b32 s50, s41, 7
  v_add_u32 v31, s50, v31
  v_mul_u32_u24 v31, 2752, v31
  v_and_b32 v19, 16, v26
  s_lshl_b32 s50, s47, 5
  v_add3_u32 v31, v31, v19, s50
  s_lshl_b32 s70, s41, 13
  s_add_u32 s70, s70, 130368
  s_mul_i32 s51, s40, 4608
  s_add_u32 s51, s51, 111936
  v_lshl_add_u32 v19, v24, 3, s51
  ds_write_b64 v19, v[22:23]
  s_lshl_b32 s52, s45, 6
  s_lshl_b32 s51, s40, 4
  s_add_u32 s51, s51, s52
  s_add_u32 s51, s51, 1048576
  v_mov_b32 v50, s51
  s_lshl_b32 s51, s45, 3
  s_sub_u32 s51, 0x7ff, s51
  v_sub_u32 v51, s51, v21
  v_mov_b32 v27, 163136
  v_mov_b32 v30, 1
  v_xor_b32 v52, 0x40000, v28
  v_xor_b32 v53, 0x40000, v29
  s_lshl_b32 s50, s19, 10
  s_add_u32 s50, s50, 1048576
  v_add_u32 v54, s50, v26
  v_add_u32 v55, 0x2000, v54
  v_xor_b32 v56, 0x800, v54
  v_xor_b32 v57, 0x800, v55
  s_lshl_b32 s50, s19, 8
  s_xor_b32 s51, s50, 512
  s_add_u32 s50, s50, 111936
  s_add_u32 s51, s51, 111936
  v_add_u32 v58, s50, v25
  v_add_u32 v59, s51, v25
  s_mov_b32 s50, 0x3f803f80
  s_mov_b32 s51, 0x3f80
  s_mov_b32 s52, 0x3f800000
  s_mov_b32 s53, 0xffff0000
  s_mov_b32 s54, 1
  s_mov_b32 s55, 1
  s_waitcnt lgkmcnt(0)
  s_mul_i32 s39, s38, 0x9e3779b1
  s_add_u32 s39, s39, 0x7F4A7C15
  v_mov_b32 v79, s39
  s_waitcnt vmcnt(3)
  v_dot2_f32_bf16 v80, v2, s50, 0
  v_dot2_f32_bf16 v80, v3, s50, v80
  v_dot2_f32_bf16 v80, v4, s50, v80
  v_dot2_f32_bf16 v80, v5, s50, v80
  s_waitcnt vmcnt(2)
  v_dot2_f32_bf16 v80, v6, s50, v80
  v_dot2_f32_bf16 v80, v7, s50, v80
  v_dot2_f32_bf16 v80, v8, s50, v80
  v_dot2_f32_bf16 v80, v9, s50, v80
  s_waitcnt vmcnt(1)
  v_dot2_f32_bf16 v81, v2, v10, 0
  v_dot2_f32_bf16 v81, v3, v11, v81
  v_dot2_f32_bf16 v81, v4, v12, v81
  v_add_f32_dpp v80, v80, v80 row_ror:8 row_mask:0xf bank_mask:0xf
  v_dot2_f32_bf16 v81, v5, v13, v81
  s_waitcnt vmcnt(0)
  v_dot2_f32_bf16 v81, v6, v14, v81
  v_add_f32_dpp v80, v80, v80 row_ror:4 row_mask:0xf bank_mask:0xf
  v_dot2_f32_bf16 v81, v7, v15, v81
  v_dot2_f32_bf16 v81, v8, v16, v81
  v_add_f32_dpp v80, v80, v80 row_ror:2 row_mask:0xf bank_mask:0xf
  v_dot2_f32_bf16 v81, v9, v17, v81
  v_dot2_f32_bf16 v82, v10, s50, 0
  v_add_f32_dpp v80, v80, v80 row_ror:1 row_mask:0xf bank_mask:0xf
  v_dot2_f32_bf16 v82, v11, s50, v82
  v_dot2_f32_bf16 v82, v12, s50, v82
  v_mov_b32 v19, v80
  v_dot2_f32_bf16 v82, v13, s50, v82
  v_dot2_f32_bf16 v82, v14, s50, v82
  v_permlane16_swap_b32 v80, v19
  v_add_f32 v80, v80, v19
  v_mul_f32 v84, 0x3b000000, v80
  v_cvt_pk_bf16_f32 v83, 0, -v84
  v_dot2_f32_bf16 v82, v15, s50, v82
  v_dot2_f32_bf16 v82, v16, s50, v82
  v_dot2_f32_bf16 v82, v17, s50, v82
  v_dot2_f32_bf16 v86, v2, s51, v83
  v_dot2_f32_bf16 v87, v2, s52, v83
  v_dot2_f32_bf16 v88, v3, s51, v83
  v_dot2_f32_bf16 v89, v3, s52, v83
  v_dot2_f32_bf16 v90, v4, s51, v83
  v_dot2_f32_bf16 v91, v4, s52, v83
  v_dot2_f32_bf16 v92, v5, s51, v83
  v_dot2_f32_bf16 v93, v5, s52, v83
  v_dot2_f32_bf16 v94, v6, s51, v83
  v_dot2_f32_bf16 v95, v6, s52, v83
  v_dot2_f32_bf16 v96, v7, s51, v83
  v_dot2_f32_bf16 v97, v7, s52, v83
  v_dot2_f32_bf16 v98, v8, s51, v83
  v_dot2_f32_bf16 v99, v8, s52, v83
  v_dot2_f32_bf16 v100, v9, s51, v83
  v_dot2_f32_bf16 v101, v9, s52, v83
  v_fma_f32 v81, v83, v82, v81
  v_add_f32 v84, v84, v83
  v_pk_mul_f32 v[102:103], v[86:87], v[86:87]
  v_pk_fma_f32 v[102:103], v[88:89], v[88:89], v[102:103]
  v_pk_fma_f32 v[102:103], v[90:91], v[90:91], v[102:103]
  v_pk_fma_f32 v[102:103], v[92:93], v[92:93], v[102:103]
  v_pk_fma_f32 v[102:103], v[94:95], v[94:95], v[102:103]
  v_pk_fma_f32 v[102:103], v[96:97], v[96:97], v[102:103]
  v_pk_fma_f32 v[102:103], v[98:99], v[98:99], v[102:103]
  v_pk_fma_f32 v[102:103], v[100:101], v[100:101], v[102:103]
  v_add_f32 v80, v102, v103
  s_nop 1
  v_permlane16_swap_b32 v80, v81
  v_add_f32 v80, v80, v81
  s_nop 1
  v_add_f32_dpp v80, v80, v80 row_ror:8 row_mask:0xf bank_mask:0xf
  s_nop 1
  v_add_f32_dpp v80, v80, v80 row_ror:4 row_mask:0xf bank_mask:0xf
  s_nop 1
  v_add_f32_dpp v80, v80, v80 row_ror:2 row_mask:0xf bank_mask:0xf
  s_nop 1
  v_add_f32_dpp v80, v80, v80 row_ror:1 row_mask:0xf bank_mask:0xf
  v_mov_b32 v81, v80
  s_nop 1
  v_permlane16_swap_b32 v80, v81
  v_mul_f32 v80, 0x3b000000, v80
  v_fma_f32 v80, -v84, v84, v80
  v_max_f32 v80, 0, v80
  v_cvt_pk_bf16_f32 v80, 0, v80
  v_add_f32 v80, 0x3727c5ac, v80
  v_cvt_pk_bf16_f32 v80, 0, v80
  v_sqrt_f32 v80, v80
  s_nop 0
  v_cvt_pk_bf16_f32 v104, 0, v80
  v_rcp_f32 v104, v104
  v_cvt_pk_bf16_f32 v76, v83, v80
  v_cvt_pk_bf16_f32 v77, v83, v80
  v_mul_f32 v81, v81, v104
  v_cvt_pk_bf16_f32 v81, 0, v81
  v_permlane32_swap_b32 v76, v77
  v_ashrrev_i32 v19, 31, v81
  v_or_b32 v19, 0x80000000, v19
  v_xor_b32 v19, v19, v81
  v_bfi_b32 v78, s53, v19, v51
  v_bfi_b32 v19, s53, v19, v51
  s_nop 1
  v_permlane32_swap_b32 v78, v19
  v_max_u32 v78, v78, v19
  s_mov_b64 exec, 1
  global_store_dwordx4 v50, v[76:79], s[32:33] sc1
  s_mov_b64 exec, -1
  s_lshl_b32 s64, s36, 16
  s_and_b32 s65, s36, 0xffff0000
  s_lshl_b32 s66, s37, 16
  s_and_b32 s67, s37, 0xffff0000
  s_setprio 0
  s_mov_b64 exec, 1
  ds_add_u32 v27, v30 offset:116
  s_mov_b64 exec, -1
  s_mov_b32 s62, 65536
L_PC4:
  ds_read_b32 v19, v27 offset:116
  s_waitcnt lgkmcnt(0)
  v_cmp_gt_u32 vcc, 4, v19
  s_cbranch_vccz L_PC4_OK
  s_sub_u32 s62, s62, 1
  s_cbranch_scc0 L_PC4
L_PC4_OK:
  s_cmp_eq_u64 s[48:49], 0
  s_cbranch_scc1 L_NF0
  s_mov_b64 exec, s[48:49]
  s_add_u32 m0, s70, 0
  s_nop 0
  global_load_lds_dwordx4 v31, s[22:23]
  s_add_u32 m0, s70, 4096
  s_nop 0
  global_load_lds_dwordx4 v31, s[24:25]
  s_mov_b64 exec, -1
  v_add_u32 v31, 88064, v31
  s_mov_b64 exec, s[48:49]
  s_add_u32 m0, s70, 1024
  s_nop 0
  global_load_lds_dwordx4 v31, s[22:23]
  s_add_u32 m0, s70, 5120
  s_nop 0
  global_load_lds_dwordx4 v31, s[24:25]
  s_mov_b64 exec, -1
  v_add_u32 v31, 88064, v31
  s_mov_b64 exec, s[48:49]
  s_add_u32 m0, s70, 2048
  s_nop 0
  global_load_lds_dwordx4 v31, s[22:23]
  s_add_u32 m0, s70, 6144
  s_nop 0
  global_load_lds_dwordx4 v31, s[24:25]
  s_mov_b64 exec, -1
  v_add_u32 v31, 88064, v31
  s_mov_b64 exec, s[48:49]
  s_add_u32 m0, s70, 3072
  s_nop 0
  global_load_lds_dwordx4 v31, s[22:23]
  s_add_u32 m0, s70, 7168
  s_nop 0
  global_load_lds_dwordx4 v31, s[24:25]
  s_mov_b64 exec, -1
  s_mov_b64 exec, s[48:49]
  global_load_dword v32, v48, s[26:27] offset:-4096
  global_load_dword v33, v48, s[26:27] offset:-3072
  global_load_dword v34, v48, s[26:27] offset:-2048
  global_load_dword v35, v48, s[26:27] offset:-1024
  global_load_dword v36, v48, s[26:27] offset:0
  global_load_dword v37, v48, s[26:27] offset:1024
  global_load_dword v38, v48, s[26:27] offset:2048
  global_load_dword v39, v48, s[26:27] offset:3072
  global_load_dword v40, v49, s[26:27] offset:-4096
  global_load_dword v41, v49, s[26:27] offset:-3072
  global_load_dword v42, v49, s[26:27] offset:-2048
  global_load_dword v43, v49, s[26:27] offset:-1024
  global_load_dword v44, v49, s[26:27] offset:0
  global_load_dword v45, v49, s[26:27] offset:1024
  global_load_dword v46, v49, s[26:27] offset:2048
  global_load_dword v47, v49, s[26:27] offset:3072
  s_mov_b64 exec, -1
  s_waitcnt vmcnt(0)
  s_branch L_J0
L_NF0:
  global_load_dwordx2 v[60:61], v28, s[4:5] offset:0
  global_load_dwordx2 v[62:63], v28, s[4:5] offset:1024
  global_load_dwordx2 v[64:65], v29, s[4:5] offset:0
  global_load_dwordx2 v[66:67], v29, s[4:5] offset:1024
  global_load_dwordx2 v[68:69], v52, s[4:5] offset:0
  global_load_dwordx2 v[70:71], v52, s[4:5] offset:1024
  global_load_dwordx2 v[72:73], v53, s[4:5] offset:0
  global_load_dwordx2 v[74:75], v53, s[4:5] offset:1024
  s_waitcnt vmcnt(0)
L_J0:
  s_mov_b32 s62, 65536
L_LOOP:
  global_load_dwordx4 v[2:5], v54, s[32:33] sc1
  global_load_dwordx4 v[6:9], v55, s[32:33] sc1
  global_load_dwordx4 v[10:13], v56, s[32:33] sc1
  global_load_dwordx4 v[14:17], v57, s[32:33] sc1
  s_waitcnt vmcnt(3)
  v_xor_b32 v19, s39, v5
  s_waitcnt vmcnt(2)
  v_bitop3_b32 v19, v19, v9, s39 bitop3:0xf6
  s_waitcnt vmcnt(1)
  v_bitop3_b32 v19, v19, v13, s39 bitop3:0xf6
  s_waitcnt vmcnt(0)
  v_bitop3_b32 v19, v19, v17, s39 bitop3:0xf6
  v_cmp_ne_u32 vcc, 0, v19
  s_cbranch_vccz L_LOOP_OK
  s_sub_u32 s62, s62, 1
  s_cbranch_scc0 L_LOOP
  s_branch L_FIN
L_LOOP_OK:
  s_setprio 3
  v_max3_u32 v19, v4, v8, v12
  v_max_u32 v19, v19, v16
  s_nop 1
  v_max_u32_dpp v19, v19, v19 row_shr:1 row_mask:0xf bank_mask:0xf
  s_nop 1
  v_max_u32_dpp v19, v19, v19 row_shr:2 row_mask:0xf bank_mask:0xf
  s_nop 1
  v_max_u32_dpp v19, v19, v19 row_shr:4 row_mask:0xf bank_mask:0xf
  s_nop 1
  v_max_u32_dpp v19, v19, v19 row_shr:8 row_mask:0xf bank_mask:0xf
  s_nop 1
  v_max_u32_dpp v19, v19, v19 row_bcast:15 row_mask:0xa bank_mask:0xf
  s_nop 1
  v_max_u32_dpp v19, v19, v19 row_bcast:31 row_mask:0xc bank_mask:0xf
  s_mov_b32 exec_lo, 0
  s_mov_b32 exec_hi, 0x80000000
  ds_max_u32 v27, v19 offset:0
  ds_add_u32 v27, v30 offset:112
  s_mov_b64 exec, -1
  s_cmp_eq_u64 s[48:49], 0
  s_cbranch_scc1 L_NF1
  s_mov_b32 s62, 65536
L_CCF:
  ds_read_b32 v19, v27 offset:112
  s_waitcnt lgkmcnt(1)
  ds_read_b32 v20, v27 offset:0
  s_waitcnt lgkmcnt(1)
  v_cmp_gt_u32 vcc, 4, v19
  s_cbranch_vccz L_CCF_OK
  s_sub_u32 s62, s62, 1
  s_cbranch_scc0 L_CCF
L_CCF_OK:
  s_waitcnt lgkmcnt(0)
  v_readfirstlane_b32 s54, v20
  s_andn2_b32 s60, 0x7ff, s54
  s_lshl_b32 s56, s60, 10
  s_lshl_b32 s55, s40, 8
  s_add_u32 s56, s56, s55
  v_add_u32 v19, s56, v25
  s_and_b32 s56, s60, 0x7fe
  s_lshl_b32 s56, s56, 3
  s_and_b32 s55, s60, 1
  s_lshl_b32 s55, s55, 2
  s_add_u32 s56, s56, s55
  s_add_u32 s56, s56, 1048576
  v_mov_b32 v21, s56
  s_mov_b64 exec, s[48:49]
  global_load_dword v18, v19, s[4:5]
  global_load_dword v50, v21, s[32:33] sc1
  s_mov_b64 exec, -1
  s_ashr_i32 s55, s54, 31
  s_not_b32 s55, s55
  s_or_b32 s55, s55, 0x80000000
  s_xor_b32 s54, s54, s55
  s_and_b32 s61, s54, 0xffff0000
  s_mov_b64 exec, 1
  ds_add_u32 v27, v30 offset:116
  s_mov_b64 exec, -1
  s_mov_b32 s62, 65536
L_PC8:
  ds_read_b32 v19, v27 offset:116
  s_waitcnt lgkmcnt(0)
  v_cmp_gt_u32 vcc, 8, v19
  s_cbranch_vccz L_PC8_OK
  s_sub_u32 s62, s62, 1
  s_cbranch_scc0 L_PC8
L_PC8_OK:
  global_load_dwordx2 v[60:61], v28, s[4:5] offset:0
  global_load_dwordx2 v[62:63], v28, s[4:5] offset:1024
  global_load_dwordx2 v[64:65], v29, s[4:5] offset:0
  global_load_dwordx2 v[66:67], v29, s[4:5] offset:1024
  global_load_dwordx2 v[68:69], v52, s[4:5] offset:0
  global_load_dwordx2 v[70:71], v52, s[4:5] offset:1024
  global_load_dwordx2 v[72:73], v53, s[4:5] offset:0
  global_load_dwordx2 v[74:75], v53, s[4:5] offset:1024
  v_and_b32 v102, 15, v24
  v_lshrrev_b32 v103, 4, v24
  s_lshl_b32 s51, s41, 8
  v_lshrrev_b32 v114, 2, v102
  v_lshl_add_u32 v114, v103, 3, v114
  v_lshlrev_b32 v114, 5, v114
  v_and_b32 v115, 3, v24
  v_lshl_add_u32 v114, v115, 3, v114
  s_lshl_b32 s50, s41, 13
  s_add_u32 s50, s50, 130368
  v_add_u32 v114, s50, v114
  ds_read_b64_tr_b16 v[116:117], v114 offset:0
  ds_read_b64_tr_b16 v[118:119], v114 offset:128
  ds_read_b64_tr_b16 v[120:121], v114 offset:1024
  ds_read_b64_tr_b16 v[122:123], v114 offset:1152
  ds_read_b64_tr_b16 v[124:125], v114 offset:2048
  ds_read_b64_tr_b16 v[126:127], v114 offset:2176
  ds_read_b64_tr_b16 v[128:129], v114 offset:3072
  ds_read_b64_tr_b16 v[130:131], v114 offset:3200
  ds_read_b64_tr_b16 v[132:133], v114 offset:4096
  ds_read_b64_tr_b16 v[134:135], v114 offset:4224
  ds_read_b64_tr_b16 v[136:137], v114 offset:5120
  ds_read_b64_tr_b16 v[138:139], v114 offset:5248
  ds_read_b64_tr_b16 v[140:141], v114 offset:6144
  ds_read_b64_tr_b16 v[142:143], v114 offset:6272
  ds_read_b64_tr_b16 v[144:145], v114 offset:7168
  ds_read_b64_tr_b16 v[146:147], v114 offset:7296
  v_add_u32 v148, s50, v25
  v_lshl_add_u32 v115, v103, 4, s50
  s_mov_b32 s52, 0x05040100
  s_mov_b32 s53, 0x07060302
  v_perm_b32 v150, v33, v32, s52
  v_perm_b32 v158, v33, v32, s53
  v_perm_b32 v151, v35, v34, s52
  v_perm_b32 v159, v35, v34, s53
  v_perm_b32 v152, v37, v36, s52
  v_perm_b32 v160, v37, v36, s53
  v_perm_b32 v153, v39, v38, s52
  v_perm_b32 v161, v39, v38, s53
  v_perm_b32 v154, v41, v40, s52
  v_perm_b32 v162, v41, v40, s53
  v_perm_b32 v155, v43, v42, s52
  v_perm_b32 v163, v43, v42, s53
  v_perm_b32 v156, v45, v44, s52
  v_perm_b32 v164, v45, v44, s53
  v_perm_b32 v157, v47, v46, s52
  v_perm_b32 v165, v47, v46, s53
  v_lshlrev_b32 v149, 4, v102
  v_add_u32 v149, 163328, v149
  s_lshl_b32 s52, s41, 2
  v_add_u32 v166, s52, v149
  v_lshrrev_b32 v167, 1, v24
  s_lshl_b32 s52, s41, 5
  v_add_u32 v167, s52, v167
  v_mul_u32_u24 v167, 3072, v167
  v_and_b32 v19, 16, v26
  s_lshl_b32 s52, s47, 5
  s_add_u32 s52, s52, 24576
  v_add3_u32 v167, v167, v19, s52
  s_waitcnt vmcnt(8)
  v_and_b32 v51, 0xffff0000, v50
  v_lshlrev_b32 v50, 16, v50
  v_rcp_f32 v51, v51
  v_lshlrev_b32 v100, 16, v18
  v_and_b32 v101, 0xffff0000, v18
  v_pk_add_f32 v[100:101], v[100:101], v[50:51] op_sel_hi:[1,0]
  v_cvt_pk_bf16_f32 v100, 0, v100
  v_cvt_pk_bf16_f32 v101, 0, v101
  v_pk_mul_f32 v[100:101], v[100:101], v[50:51] op_sel:[0,1] op_sel_hi:[1,1]
  v_cvt_pk_bf16_f32 v18, v100, v101
  ds_write_b32 v148, v18
  ds_read_b128 v[32:35], v115 offset:0
  ds_read_b128 v[36:39], v115 offset:64
  ds_read_b128 v[40:43], v115 offset:128
  ds_read_b128 v[44:47], v115 offset:192
  s_waitcnt lgkmcnt(3)
  v_mfma_f32_16x16x32_bf16 v[168:171], v[32:35], v[116:119], 0
  v_mfma_f32_16x16x32_bf16 v[172:175], v[32:35], v[132:135], 0
  s_waitcnt lgkmcnt(2)
  v_mfma_f32_16x16x32_bf16 v[168:171], v[36:39], v[120:123], v[168:171]
  v_mfma_f32_16x16x32_bf16 v[172:175], v[36:39], v[136:139], v[172:175]
  s_waitcnt lgkmcnt(1)
  v_mfma_f32_16x16x32_bf16 v[168:171], v[40:43], v[124:127], v[168:171]
  v_mfma_f32_16x16x32_bf16 v[172:175], v[40:43], v[140:143], v[172:175]
  s_waitcnt lgkmcnt(0)
  v_mfma_f32_16x16x32_bf16 v[168:171], v[44:47], v[128:131], v[168:171]
  v_mfma_f32_16x16x32_bf16 v[172:175], v[44:47], v[144:147], v[172:175]
  s_mov_b64 exec, 0xffff
  s_nop 5
  ds_write_b32 v166, v168
  ds_write_b32 v166, v172 offset:256
  s_mov_b64 exec, 1
  ds_add_u32 v27, v30 offset:96
  s_mov_b64 exec, -1
  s_mov_b32 s62, 65536
L_FC:
  ds_read_b32 v19, v27 offset:96
  s_waitcnt lgkmcnt(2)
  ds_read_b128 v[168:171], v149
  s_waitcnt lgkmcnt(2)
  ds_read_b128 v[172:175], v149 offset:256
  s_waitcnt lgkmcnt(2)
  v_cmp_ne_u32 vcc, 4, v19
  s_cbranch_vccz L_FC_OK
  s_sub_u32 s62, s62, 1
  s_cbranch_scc0 L_FC
L_FC_OK:
  s_waitcnt lgkmcnt(1)
  v_pk_add_f32 v[168:169], v[168:169], v[170:171]
  s_waitcnt lgkmcnt(0)
  v_pk_add_f32 v[172:173], v[172:173], v[174:175]
  v_add_f32 v168, v168, v169
  v_add_f32 v172, v172, v173
  v_cvt_pk_bf16_f32 v168, 0, v168
  v_cvt_pk_bf16_f32 v172, 0, v172
  v_mul_f32 v169, 0xbfb8aa3b, v168
  v_exp_f32 v169, v169
  s_nop 0
  v_add_f32 v169, 1.0, v169
  v_rcp_f32 v169, v169
  s_nop 0
  v_mul_f32 v168, v168, v169
  v_cvt_pk_bf16_f32 v168, 0, v168
  v_mul_f32 v168, v168, v172
  s_nop 1
  v_mov_b32_dpp v169, v168 quad_perm:[1,0,3,2] row_mask:0xf bank_mask:0xf
  v_cvt_pk_bf16_f32 v168, v168, v169
  s_nop 0
  v_readlane_b32 s50, v168, 0
  v_readlane_b32 s51, v168, 2
  v_readlane_b32 s52, v168, 4
  v_readlane_b32 s53, v168, 6
  v_readlane_b32 s54, v168, 8
  v_readlane_b32 s55, v168, 10
  v_readlane_b32 s56, v168, 12
  v_readlane_b32 s57, v168, 14
  v_mov_b32 v33, s39
  v_mov_b32 v35, s39
  v_dot2_f32_bf16 v32, v150, s50, 0
  v_dot2_f32_bf16 v34, v158, s50, 0
  v_dot2_f32_bf16 v32, v151, s51, v32
  v_dot2_f32_bf16 v34, v159, s51, v34
  v_dot2_f32_bf16 v32, v152, s52, v32
  v_dot2_f32_bf16 v34, v160, s52, v34
  v_dot2_f32_bf16 v32, v153, s53, v32
  v_dot2_f32_bf16 v34, v161, s53, v34
  v_dot2_f32_bf16 v32, v154, s54, v32
  v_dot2_f32_bf16 v34, v162, s54, v34
  v_dot2_f32_bf16 v32, v155, s55, v32
  v_dot2_f32_bf16 v34, v163, s55, v34
  v_dot2_f32_bf16 v32, v156, s56, v32
  v_dot2_f32_bf16 v34, v164, s56, v34
  v_dot2_f32_bf16 v32, v157, s57, v32
  v_dot2_f32_bf16 v34, v165, s57, v34
  s_nop 2
  global_store_dwordx4 v167, v[32:35], s[32:33] sc1
  s_mov_b32 s51, 0x3f80
  s_mov_b32 s52, 0x3f800000
  s_mov_b32 s53, 0xffff0000
L_NF1:
  v_and_b32 v104, s53, v2
  v_lshlrev_b32 v22, 16, v2
  v_rcp_f32 v104, v104
  v_and_b32 v105, s53, v3
  v_lshlrev_b32 v23, 16, v3
  v_rcp_f32 v105, v105
  s_waitcnt vmcnt(8)
  v_dot2_f32_bf16 v76, v60, s51, v22
  s_waitcnt vmcnt(7)
  v_dot2_f32_bf16 v77, v62, s51, v23
  v_dot2_f32_bf16 v78, v60, s52, v22
  v_dot2_f32_bf16 v79, v62, s52, v23
  v_dot2_f32_bf16 v80, v61, s51, v22
  v_dot2_f32_bf16 v81, v63, s51, v23
  v_dot2_f32_bf16 v82, v61, s52, v22
  v_dot2_f32_bf16 v83, v63, s52, v23
  v_cvt_pk_bf16_f32 v76, 0, v76
  v_cvt_pk_bf16_f32 v77, 0, v77
  v_cvt_pk_bf16_f32 v78, 0, v78
  v_cvt_pk_bf16_f32 v79, 0, v79
  v_cvt_pk_bf16_f32 v80, 0, v80
  v_cvt_pk_bf16_f32 v81, 0, v81
  v_cvt_pk_bf16_f32 v82, 0, v82
  v_cvt_pk_bf16_f32 v83, 0, v83
  v_pk_mul_f32 v[76:77], v[76:77], v[104:105]
  v_pk_mul_f32 v[78:79], v[78:79], v[104:105]
  v_pk_mul_f32 v[80:81], v[80:81], v[104:105]
  v_pk_mul_f32 v[82:83], v[82:83], v[104:105]
  v_cvt_pk_bf16_f32 v76, 0, v76
  v_cvt_pk_bf16_f32 v77, 0, v77
  v_cvt_pk_bf16_f32 v78, 0, v78
  v_cvt_pk_bf16_f32 v79, 0, v79
  v_cvt_pk_bf16_f32 v80, 0, v80
  v_cvt_pk_bf16_f32 v81, 0, v81
  v_cvt_pk_bf16_f32 v82, 0, v82
  v_cvt_pk_bf16_f32 v83, 0, v83
  v_cvt_pk_f16_f32 v106, v76, v77
  v_cvt_pk_f16_f32 v108, v78, v79
  v_cvt_pk_f16_f32 v110, v80, v81
  v_cvt_pk_f16_f32 v112, v82, v83
  v_and_b32 v104, s53, v6
  v_lshlrev_b32 v22, 16, v6
  v_rcp_f32 v104, v104
  v_and_b32 v105, s53, v7
  v_lshlrev_b32 v23, 16, v7
  v_rcp_f32 v105, v105
  s_waitcnt vmcnt(6)
  v_dot2_f32_bf16 v84, v64, s51, v22
  s_waitcnt vmcnt(5)
  v_dot2_f32_bf16 v85, v66, s51, v23
  v_dot2_f32_bf16 v86, v64, s52, v22
  v_dot2_f32_bf16 v87, v66, s52, v23
  v_dot2_f32_bf16 v88, v65, s51, v22
  v_dot2_f32_bf16 v89, v67, s51, v23
  v_dot2_f32_bf16 v90, v65, s52, v22
  v_dot2_f32_bf16 v91, v67, s52, v23
  v_cvt_pk_bf16_f32 v84, 0, v84
  v_cvt_pk_bf16_f32 v85, 0, v85
  v_cvt_pk_bf16_f32 v86, 0, v86
  v_cvt_pk_bf16_f32 v87, 0, v87
  v_cvt_pk_bf16_f32 v88, 0, v88
  v_cvt_pk_bf16_f32 v89, 0, v89
  v_cvt_pk_bf16_f32 v90, 0, v90
  v_cvt_pk_bf16_f32 v91, 0, v91
  v_pk_mul_f32 v[84:85], v[84:85], v[104:105]
  v_pk_mul_f32 v[86:87], v[86:87], v[104:105]
  v_pk_mul_f32 v[88:89], v[88:89], v[104:105]
  v_pk_mul_f32 v[90:91], v[90:91], v[104:105]
  v_cvt_pk_bf16_f32 v84, 0, v84
  v_cvt_pk_bf16_f32 v85, 0, v85
  v_cvt_pk_bf16_f32 v86, 0, v86
  v_cvt_pk_bf16_f32 v87, 0, v87
  v_cvt_pk_bf16_f32 v88, 0, v88
  v_cvt_pk_bf16_f32 v89, 0, v89
  v_cvt_pk_bf16_f32 v90, 0, v90
  v_cvt_pk_bf16_f32 v91, 0, v91
  v_cvt_pk_f16_f32 v107, v84, v85
  ds_write2st64_b32 v58, v106, v107 offset0:2 offset1:10
  v_cvt_pk_f16_f32 v109, v86, v87
  ds_write2st64_b32 v58, v108, v109 offset0:20 offset1:28
  v_cvt_pk_f16_f32 v111, v88, v89
  ds_write2st64_b32 v58, v110, v111 offset0:38 offset1:46
  v_cvt_pk_f16_f32 v113, v90, v91
  ds_write2st64_b32 v58, v112, v113 offset0:56 offset1:64
  v_and_b32 v104, s53, v10
  v_lshlrev_b32 v22, 16, v10
  v_rcp_f32 v104, v104
  v_and_b32 v105, s53, v11
  v_lshlrev_b32 v23, 16, v11
  v_rcp_f32 v105, v105
  s_waitcnt vmcnt(4)
  v_dot2_f32_bf16 v92, v68, s51, v22
  s_waitcnt vmcnt(3)
  v_dot2_f32_bf16 v93, v70, s51, v23
  v_dot2_f32_bf16 v94, v68, s52, v22
  v_dot2_f32_bf16 v95, v70, s52, v23
  v_dot2_f32_bf16 v96, v69, s51, v22
  v_dot2_f32_bf16 v97, v71, s51, v23
  v_dot2_f32_bf16 v98, v69, s52, v22
  v_dot2_f32_bf16 v99, v71, s52, v23
  v_cvt_pk_bf16_f32 v92, 0, v92
  v_cvt_pk_bf16_f32 v93, 0, v93
  v_cvt_pk_bf16_f32 v94, 0, v94
  v_cvt_pk_bf16_f32 v95, 0, v95
  v_cvt_pk_bf16_f32 v96, 0, v96
  v_cvt_pk_bf16_f32 v97, 0, v97
  v_cvt_pk_bf16_f32 v98, 0, v98
  v_cvt_pk_bf16_f32 v99, 0, v99
  v_pk_mul_f32 v[92:93], v[92:93], v[104:105]
  v_pk_mul_f32 v[94:95], v[94:95], v[104:105]
  v_pk_mul_f32 v[96:97], v[96:97], v[104:105]
  v_pk_mul_f32 v[98:99], v[98:99], v[104:105]
  v_cvt_pk_bf16_f32 v92, 0, v92
  v_cvt_pk_bf16_f32 v93, 0, v93
  v_cvt_pk_bf16_f32 v94, 0, v94
  v_cvt_pk_bf16_f32 v95, 0, v95
  v_cvt_pk_bf16_f32 v96, 0, v96
  v_cvt_pk_bf16_f32 v97, 0, v97
  v_cvt_pk_bf16_f32 v98, 0, v98
  v_cvt_pk_bf16_f32 v99, 0, v99
  v_cvt_pk_f16_f32 v106, v92, v93
  v_cvt_pk_f16_f32 v108, v94, v95
  v_cvt_pk_f16_f32 v110, v96, v97
  v_cvt_pk_f16_f32 v112, v98, v99
  v_and_b32 v104, s53, v14
  v_lshlrev_b32 v22, 16, v14
  v_rcp_f32 v104, v104
  v_and_b32 v105, s53, v15
  v_lshlrev_b32 v23, 16, v15
  v_rcp_f32 v105, v105
  s_waitcnt vmcnt(2)
  v_dot2_f32_bf16 v92, v72, s51, v22
  s_waitcnt vmcnt(1)
  v_dot2_f32_bf16 v93, v74, s51, v23
  v_dot2_f32_bf16 v94, v72, s52, v22
  v_dot2_f32_bf16 v95, v74, s52, v23
  v_dot2_f32_bf16 v96, v73, s51, v22
  v_dot2_f32_bf16 v97, v75, s51, v23
  v_dot2_f32_bf16 v98, v73, s52, v22
  v_dot2_f32_bf16 v99, v75, s52, v23
  v_cvt_pk_bf16_f32 v92, 0, v92
  v_cvt_pk_bf16_f32 v93, 0, v93
  v_cvt_pk_bf16_f32 v94, 0, v94
  v_cvt_pk_bf16_f32 v95, 0, v95
  v_cvt_pk_bf16_f32 v96, 0, v96
  v_cvt_pk_bf16_f32 v97, 0, v97
  v_cvt_pk_bf16_f32 v98, 0, v98
  v_cvt_pk_bf16_f32 v99, 0, v99
  v_pk_mul_f32 v[92:93], v[92:93], v[104:105]
  v_pk_mul_f32 v[94:95], v[94:95], v[104:105]
  v_pk_mul_f32 v[96:97], v[96:97], v[104:105]
  v_pk_mul_f32 v[98:99], v[98:99], v[104:105]
  v_cvt_pk_bf16_f32 v92, 0, v92
  v_cvt_pk_bf16_f32 v93, 0, v93
  v_cvt_pk_bf16_f32 v94, 0, v94
  v_cvt_pk_bf16_f32 v95, 0, v95
  v_cvt_pk_bf16_f32 v96, 0, v96
  v_cvt_pk_bf16_f32 v97, 0, v97
  v_cvt_pk_bf16_f32 v98, 0, v98
  v_cvt_pk_bf16_f32 v99, 0, v99
  v_cvt_pk_f16_f32 v107, v92, v93
  ds_write2st64_b32 v59, v106, v107 offset0:2 offset1:10
  v_cvt_pk_f16_f32 v109, v94, v95
  ds_write2st64_b32 v59, v108, v109 offset0:20 offset1:28
  v_cvt_pk_f16_f32 v111, v96, v97
  ds_write2st64_b32 v59, v110, v111 offset0:38 offset1:46
  v_cvt_pk_f16_f32 v113, v98, v99
  ds_write2st64_b32 v59, v112, v113 offset0:56 offset1:64
  s_mov_b64 exec, 1
  ds_add_u32 v27, v30 offset:16
  s_mov_b64 exec, -1
  s_mov_b32 s62, 65536
L_CC:
  ds_read_b32 v19, v27 offset:112
  s_waitcnt lgkmcnt(1)
  ds_read_b32 v20, v27 offset:0
  s_waitcnt lgkmcnt(1)
  v_cmp_gt_u32 vcc, 4, v19
  s_cbranch_vccz L_CC_OK
  s_sub_u32 s62, s62, 1
  s_cbranch_scc0 L_CC
L_CC_OK:
  s_waitcnt lgkmcnt(0)
  v_readfirstlane_b32 s54, v20
  s_andn2_b32 s60, 0x7ff, s54
  s_ashr_i32 s55, s54, 31
  s_not_b32 s55, s55
  s_or_b32 s55, s55, 0x80000000
  s_xor_b32 s54, s54, s55
  s_and_b32 s61, s54, 0xffff0000
  v_pk_mul_f32 v[68:69], v[76:77], s[64:65] op_sel_hi:[1,0]
  v_pk_mul_f32 v[70:71], v[78:79], s[64:65] op_sel:[0,1] op_sel_hi:[1,1]
  v_pk_mul_f32 v[72:73], v[80:81], s[66:67] op_sel_hi:[1,0]
  v_pk_mul_f32 v[74:75], v[82:83], s[66:67] op_sel:[0,1] op_sel_hi:[1,1]
  v_cvt_pk_bf16_f32 v68, 0, v68
  v_cvt_pk_bf16_f32 v69, 0, v69
  v_cvt_pk_bf16_f32 v70, 0, v70
  v_cvt_pk_bf16_f32 v71, 0, v71
  v_cvt_pk_bf16_f32 v72, 0, v72
  v_cvt_pk_bf16_f32 v73, 0, v73
  v_cvt_pk_bf16_f32 v74, 0, v74
  v_cvt_pk_bf16_f32 v75, 0, v75
  s_mov_b32 s96, 0xbfb8aa3b
  v_pk_mul_f32 v[100:101], v[76:77], s[96:97] op_sel_hi:[1,0]
  v_pk_mul_f32 v[102:103], v[78:79], s[96:97] op_sel_hi:[1,0]
  v_pk_mul_f32 v[104:105], v[80:81], s[96:97] op_sel_hi:[1,0]
  v_pk_mul_f32 v[106:107], v[82:83], s[96:97] op_sel_hi:[1,0]
  v_exp_f32 v100, v100
  v_exp_f32 v101, v101
  v_exp_f32 v102, v102
  v_exp_f32 v103, v103
  v_exp_f32 v104, v104
  v_exp_f32 v105, v105
  v_exp_f32 v106, v106
  v_exp_f32 v107, v107
  v_pk_add_f32 v[100:101], v[100:101], 1.0 op_sel_hi:[1,0]
  v_pk_add_f32 v[102:103], v[102:103], 1.0 op_sel_hi:[1,0]
  v_pk_add_f32 v[104:105], v[104:105], 1.0 op_sel_hi:[1,0]
  v_pk_add_f32 v[106:107], v[106:107], 1.0 op_sel_hi:[1,0]
  v_rcp_f32 v100, v100
  v_rcp_f32 v101, v101
  v_rcp_f32 v102, v102
  v_rcp_f32 v103, v103
  v_rcp_f32 v104, v104
  v_rcp_f32 v105, v105
  v_rcp_f32 v106, v106
  v_rcp_f32 v107, v107
  v_pk_mul_f32 v[100:101], v[100:101], v[76:77]
  v_pk_mul_f32 v[102:103], v[102:103], v[78:79]
  v_pk_mul_f32 v[104:105], v[104:105], v[80:81]
  v_pk_mul_f32 v[106:107], v[106:107], v[82:83]
  v_cvt_pk_bf16_f32 v100, 0, v100
  v_cvt_pk_bf16_f32 v101, 0, v101
  v_cvt_pk_bf16_f32 v102, 0, v102
  v_cvt_pk_bf16_f32 v103, 0, v103
  v_cvt_pk_bf16_f32 v104, 0, v104
  v_cvt_pk_bf16_f32 v105, 0, v105
  v_cvt_pk_bf16_f32 v106, 0, v106
  v_cvt_pk_bf16_f32 v107, 0, v107
  s_setprio 0
  s_or_b32 s50, s2, s40
  s_cmp_eq_u32 s50, 0
  s_cselect_b64 exec, 1, 0
  s_add_u32 s51, s38, 1
  v_mov_b32 v19, 0
  v_mov_b32 v20, s51
  global_store_dword v19, v20, s[32:33] sc1
  s_mov_b64 exec, -1
  s_lshr_b32 s50, s40, 1
  s_lshl_b32 s51, s50, 12
  s_and_b32 s52, s40, 1
  s_lshl_b32 s52, s52, 9
  s_add_u32 s51, s51, s52
  s_add_u32 s51, s51, 8192
  v_lshl_add_u32 v6, v24, 3, s51
  s_lshl_b32 s50, s50, 4
  v_add_u32 v27, s50, v27
  v_pk_mul_f32 v[92:93], v[84:85], s[64:65] op_sel_hi:[1,0]
  v_pk_mul_f32 v[94:95], v[86:87], s[64:65] op_sel:[0,1] op_sel_hi:[1,1]
  v_pk_mul_f32 v[96:97], v[88:89], s[66:67] op_sel_hi:[1,0]
  v_pk_mul_f32 v[98:99], v[90:91], s[66:67] op_sel:[0,1] op_sel_hi:[1,1]
  v_cvt_pk_bf16_f32 v92, 0, v92
  v_cvt_pk_bf16_f32 v93, 0, v93
  v_cvt_pk_bf16_f32 v94, 0, v94
  v_cvt_pk_bf16_f32 v95, 0, v95
  v_cvt_pk_bf16_f32 v96, 0, v96
  v_cvt_pk_bf16_f32 v97, 0, v97
  v_cvt_pk_bf16_f32 v98, 0, v98
  v_cvt_pk_bf16_f32 v99, 0, v99
  s_mov_b32 s96, 0xbfb8aa3b
  v_pk_mul_f32 v[108:109], v[84:85], s[96:97] op_sel_hi:[1,0]
  v_pk_mul_f32 v[110:111], v[86:87], s[96:97] op_sel_hi:[1,0]
  v_pk_mul_f32 v[112:113], v[88:89], s[96:97] op_sel_hi:[1,0]
  v_pk_mul_f32 v[114:115], v[90:91], s[96:97] op_sel_hi:[1,0]
  v_exp_f32 v108, v108
  v_exp_f32 v109, v109
  v_exp_f32 v110, v110
  v_exp_f32 v111, v111
  v_exp_f32 v112, v112
  v_exp_f32 v113, v113
  v_exp_f32 v114, v114
  v_exp_f32 v115, v115
  v_pk_add_f32 v[108:109], v[108:109], 1.0 op_sel_hi:[1,0]
  v_pk_add_f32 v[110:111], v[110:111], 1.0 op_sel_hi:[1,0]
  v_pk_add_f32 v[112:113], v[112:113], 1.0 op_sel_hi:[1,0]
  v_pk_add_f32 v[114:115], v[114:115], 1.0 op_sel_hi:[1,0]
  v_rcp_f32 v108, v108
  v_rcp_f32 v109, v109
  v_rcp_f32 v110, v110
  v_rcp_f32 v111, v111
  v_rcp_f32 v112, v112
  v_rcp_f32 v113, v113
  v_rcp_f32 v114, v114
  v_rcp_f32 v115, v115
  v_pk_mul_f32 v[108:109], v[108:109], v[84:85]
  v_pk_mul_f32 v[110:111], v[110:111], v[86:87]
  v_pk_mul_f32 v[112:113], v[112:113], v[88:89]
  v_pk_mul_f32 v[114:115], v[114:115], v[90:91]
  v_cvt_pk_bf16_f32 v108, 0, v108
  v_cvt_pk_bf16_f32 v109, 0, v109
  v_cvt_pk_bf16_f32 v110, 0, v110
  v_cvt_pk_bf16_f32 v111, 0, v111
  v_cvt_pk_bf16_f32 v112, 0, v112
  v_cvt_pk_bf16_f32 v113, 0, v113
  v_cvt_pk_bf16_f32 v114, 0, v114
  v_cvt_pk_bf16_f32 v115, 0, v115
  v_lshlrev_b32 v8, 16, v60
  v_lshlrev_b32 v9, 16, v62
  v_and_b32 v10, 0xffff0000, v60
  v_and_b32 v11, 0xffff0000, v62
  v_lshlrev_b32 v12, 16, v61
  v_lshlrev_b32 v13, 16, v63
  v_and_b32 v14, 0xffff0000, v61
  v_and_b32 v15, 0xffff0000, v63
  v_lshlrev_b32 v52, 16, v64
  v_lshlrev_b32 v53, 16, v66
  v_and_b32 v54, 0xffff0000, v64
  v_and_b32 v55, 0xffff0000, v66
  v_lshlrev_b32 v56, 16, v65
  v_lshlrev_b32 v57, 16, v67
  v_and_b32 v58, 0xffff0000, v65
  v_and_b32 v59, 0xffff0000, v67
  s_lshr_b32 s71, s60, 7
  s_sub_u32 s71, s71, s19
  s_cmp_eq_u32 s71, 0
  s_cbranch_scc0 L_NOWN0
  s_mul_i32 s50, s42, 3072
  s_add_u32 s50, s50, 24576
  v_add_u32 v16, s50, v26
  v_mov_b32 v48, 0
  v_mov_b32 v49, s39
  v_mov_b32 v50, 0
  v_mov_b32 v51, s39
  s_mov_b32 s62, 65536
L_GA0:
  global_load_dwordx4 v[40:43], v16, s[32:33] sc1
  global_load_dwordx4 v[44:47], v16, s[32:33] offset:1024 sc1
  s_mov_b32 exec_hi, 0xfff
  global_load_dwordx4 v[48:51], v16, s[32:33] offset:2048 sc1
  s_mov_b32 exec_hi, -1
  v_mov_b32 v32, s61
  v_mul_f32 v32, 0xbfb8aa3b, v32
  v_exp_f32 v32, v32
  s_bfe_u32 s50, s60, 0x60001
  s_lshl_b64 s[44:45], 1, s50
  v_add_f32 v32, 1.0, v32
  v_rcp_f32 v32, v32
  s_bitcmp1_b32 s60, 0
  s_cselect_b64 vcc, -1, 0
  s_cselect_b64 s[6:7], 0, s[44:45]
  s_cselect_b64 s[8:9], s[44:45], 0
  v_cndmask_b32 v116, v76, v77, vcc
  v_cndmask_b32 v117, v78, v79, vcc
  v_cndmask_b32 v118, v80, v81, vcc
  v_cndmask_b32 v119, v82, v83, vcc
  v_cvt_pk_bf16_f32 v32, 0, v32
  s_waitcnt vmcnt(2)
  v_xor_b32 v7, s39, v41
  v_bitop3_b32 v7, v7, v43, s39 bitop3:0xf6
  s_waitcnt vmcnt(1)
  v_bitop3_b32 v7, v7, v45, s39 bitop3:0xf6
  v_bitop3_b32 v7, v7, v47, s39 bitop3:0xf6
  s_waitcnt vmcnt(0)
  v_bitop3_b32 v7, v7, v49, s39 bitop3:0xf6
  v_bitop3_b32 v7, v7, v51, s39 bitop3:0xf6
  v_cmp_ne_u32 vcc, 0, v7
  s_cbranch_vccz L_GA0_OK
  s_sub_u32 s62, s62, 1
  s_cbranch_scc0 L_GA0
L_GA0_OK:
  v_add_f32 v40, v40, v44
  v_add_f32 v42, v42, v46
  v_add_f32 v40, v40, v48
  v_add_f32 v42, v42, v50
  s_nop 1
  v_permlane32_swap_b32 v40, v42
  v_add_f32 v40, v40, v42
  v_mov_b32 v42, v40
  s_nop 1
  v_permlane16_swap_b32 v40, v42
  v_add_f32 v40, v40, v42
  s_nop 1
  v_add_f32_dpp v40, v40, v40 row_ror:2 row_mask:0xf bank_mask:0xf
  s_nop 1
  v_add_f32_dpp v40, v40, v40 row_ror:4 row_mask:0xf bank_mask:0xf
  s_nop 1
  v_add_f32_dpp v40, v40, v40 row_ror:8 row_mask:0xf bank_mask:0xf
  v_cvt_pk_bf16_f32 v40, 0, v40
  v_mul_f32 v40, v40, v32
  v_cvt_pk_bf16_f32 v40, 0, v40
  s_nop 0
  v_readlane_b32 s50, v40, 0
  v_readlane_b32 s51, v40, 32
  v_readlane_b32 s52, v40, 1
  v_readlane_b32 s53, v40, 33
  v_pk_add_f32 v[116:117], v[116:117], s[50:51]
  s_nop 0
  v_pk_add_f32 v[118:119], v[118:119], s[52:53]
  v_cvt_pk_bf16_f32 v116, 0, v116
  v_cvt_pk_bf16_f32 v117, 0, v117
  v_cvt_pk_bf16_f32 v118, 0, v118
  v_cvt_pk_bf16_f32 v119, 0, v119
  s_mov_b32 s96, 0xbfb8aa3b
  v_pk_mul_f32 v[120:121], v[116:117], s[96:97] op_sel_hi:[1,0]
  v_pk_mul_f32 v[122:123], v[118:119], s[96:97] op_sel_hi:[1,0]
  v_exp_f32 v120, v120
  v_exp_f32 v121, v121
  v_exp_f32 v122, v122
  v_exp_f32 v123, v123
  v_pk_add_f32 v[120:121], v[120:121], 1.0 op_sel_hi:[1,0]
  v_pk_add_f32 v[122:123], v[122:123], 1.0 op_sel_hi:[1,0]
  v_rcp_f32 v120, v120
  v_rcp_f32 v121, v121
  v_rcp_f32 v122, v122
  v_rcp_f32 v123, v123
  v_pk_mul_f32 v[120:121], v[120:121], v[116:117]
  v_pk_mul_f32 v[122:123], v[122:123], v[118:119]
  v_cvt_pk_bf16_f32 v120, 0, v120
  v_cvt_pk_bf16_f32 v121, 0, v121
  v_cvt_pk_bf16_f32 v122, 0, v122
  v_cvt_pk_bf16_f32 v123, 0, v123
  v_cndmask_b32 v100, v100, v120, s[6:7]
  v_cndmask_b32 v102, v102, v121, s[6:7]
  v_cndmask_b32 v104, v104, v122, s[6:7]
  v_cndmask_b32 v106, v106, v123, s[6:7]
  v_cndmask_b32 v101, v101, v120, s[8:9]
  v_cndmask_b32 v103, v103, v121, s[8:9]
  v_cndmask_b32 v105, v105, v122, s[8:9]
  v_cndmask_b32 v107, v107, v123, s[8:9]
L_NOWN0:
  s_mov_b32 s62, 65536
L_EX0:
  ds_read_b32 v7, v27 offset:32
  s_waitcnt lgkmcnt(0)
  v_cmp_ne_u32 vcc, 4, v7
  s_cbranch_vccz L_EX0_OK
  s_sub_u32 s62, s62, 1
  s_cbranch_scc0 L_EX0
L_EX0_OK:
  v_mov_b32 v7, 163136
  ds_read_b128 v[2:5], v7 offset:128
  ds_read_b64 v[32:33], v6 offset:0
  ds_read_b64 v[34:35], v6 offset:1024
  ds_read_b64 v[36:37], v6 offset:2048
  ds_read_b64 v[38:39], v6 offset:3072
  s_waitcnt lgkmcnt(3)
  v_cvt_pk_bf16_f32 v32, 0, v32
  v_cvt_pk_bf16_f32 v33, 0, v33
  s_waitcnt lgkmcnt(2)
  v_cvt_pk_bf16_f32 v34, 0, v34
  v_cvt_pk_bf16_f32 v35, 0, v35
  s_waitcnt lgkmcnt(1)
  v_cvt_pk_bf16_f32 v36, 0, v36
  v_cvt_pk_bf16_f32 v37, 0, v37
  s_waitcnt lgkmcnt(0)
  v_cvt_pk_bf16_f32 v38, 0, v38
  v_cvt_pk_bf16_f32 v39, 0, v39
  v_pk_fma_f32 v[32:33], v[32:33], v[2:3], v[68:69] op_sel_hi:[1,0,1]
  v_pk_fma_f32 v[34:35], v[34:35], v[2:3], v[70:71] op_sel:[0,1,0] op_sel_hi:[1,1,1]
  v_pk_fma_f32 v[36:37], v[36:37], v[4:5], v[72:73] op_sel_hi:[1,0,1]
  v_pk_fma_f32 v[38:39], v[38:39], v[4:5], v[74:75] op_sel:[0,1,0] op_sel_hi:[1,1,1]
  v_cvt_pk_bf16_f32 v68, 0, v32
  v_cvt_pk_bf16_f32 v69, 0, v33
  v_cvt_pk_bf16_f32 v70, 0, v34
  v_cvt_pk_bf16_f32 v71, 0, v35
  v_cvt_pk_bf16_f32 v72, 0, v36
  v_cvt_pk_bf16_f32 v73, 0, v37
  v_cvt_pk_bf16_f32 v74, 0, v38
  v_cvt_pk_bf16_f32 v75, 0, v39
  v_pk_mul_f32 v[32:33], v[68:69], v[100:101]
  v_pk_mul_f32 v[34:35], v[70:71], v[102:103]
  v_pk_mul_f32 v[36:37], v[72:73], v[104:105]
  v_pk_mul_f32 v[38:39], v[74:75], v[106:107]
  v_cvt_pk_bf16_f32 v32, 0, v32
  v_cvt_pk_bf16_f32 v33, 0, v33
  v_cvt_pk_bf16_f32 v34, 0, v34
  v_cvt_pk_bf16_f32 v35, 0, v35
  v_cvt_pk_bf16_f32 v36, 0, v36
  v_cvt_pk_bf16_f32 v37, 0, v37
  v_cvt_pk_bf16_f32 v38, 0, v38
  v_cvt_pk_bf16_f32 v39, 0, v39
  v_pk_add_f32 v[32:33], v[32:33], v[8:9]
  v_pk_add_f32 v[34:35], v[34:35], v[10:11]
  v_pk_add_f32 v[36:37], v[36:37], v[12:13]
  v_pk_add_f32 v[38:39], v[38:39], v[14:15]
  v_cvt_pk_bf16_f32 v100, v32, v34
  v_cvt_pk_bf16_f32 v101, v36, v38
  global_store_dwordx2 v28, v[100:101], s[28:29] offset:0
  v_cvt_pk_bf16_f32 v102, v33, v35
  v_cvt_pk_bf16_f32 v103, v37, v39
  global_store_dwordx2 v28, v[102:103], s[28:29] offset:1024
  s_cmp_eq_u32 s71, 8
  s_cbranch_scc0 L_NOWN1
  s_mul_i32 s50, s42, 3072
  s_add_u32 s50, s50, 24576
  v_add_u32 v16, s50, v26
  v_mov_b32 v48, 0
  v_mov_b32 v49, s39
  v_mov_b32 v50, 0
  v_mov_b32 v51, s39
  s_mov_b32 s62, 65536
L_GA1:
  global_load_dwordx4 v[40:43], v16, s[32:33] sc1
  global_load_dwordx4 v[44:47], v16, s[32:33] offset:1024 sc1
  s_mov_b32 exec_hi, 0xfff
  global_load_dwordx4 v[48:51], v16, s[32:33] offset:2048 sc1
  s_mov_b32 exec_hi, -1
  v_mov_b32 v32, s61
  v_mul_f32 v32, 0xbfb8aa3b, v32
  v_exp_f32 v32, v32
  s_bfe_u32 s50, s60, 0x60001
  s_lshl_b64 s[44:45], 1, s50
  v_add_f32 v32, 1.0, v32
  v_rcp_f32 v32, v32
  s_bitcmp1_b32 s60, 0
  s_cselect_b64 vcc, -1, 0
  s_cselect_b64 s[6:7], 0, s[44:45]
  s_cselect_b64 s[8:9], s[44:45], 0
  v_cndmask_b32 v116, v84, v85, vcc
  v_cndmask_b32 v117, v86, v87, vcc
  v_cndmask_b32 v118, v88, v89, vcc
  v_cndmask_b32 v119, v90, v91, vcc
  v_cvt_pk_bf16_f32 v32, 0, v32
  s_waitcnt vmcnt(2)
  v_xor_b32 v7, s39, v41
  v_bitop3_b32 v7, v7, v43, s39 bitop3:0xf6
  s_waitcnt vmcnt(1)
  v_bitop3_b32 v7, v7, v45, s39 bitop3:0xf6
  v_bitop3_b32 v7, v7, v47, s39 bitop3:0xf6
  s_waitcnt vmcnt(0)
  v_bitop3_b32 v7, v7, v49, s39 bitop3:0xf6
  v_bitop3_b32 v7, v7, v51, s39 bitop3:0xf6
  v_cmp_ne_u32 vcc, 0, v7
  s_cbranch_vccz L_GA1_OK
  s_sub_u32 s62, s62, 1
  s_cbranch_scc0 L_GA1
L_GA1_OK:
  v_add_f32 v40, v40, v44
  v_add_f32 v42, v42, v46
  v_add_f32 v40, v40, v48
  v_add_f32 v42, v42, v50
  s_nop 1
  v_permlane32_swap_b32 v40, v42
  v_add_f32 v40, v40, v42
  v_mov_b32 v42, v40
  s_nop 1
  v_permlane16_swap_b32 v40, v42
  v_add_f32 v40, v40, v42
  s_nop 1
  v_add_f32_dpp v40, v40, v40 row_ror:2 row_mask:0xf bank_mask:0xf
  s_nop 1
  v_add_f32_dpp v40, v40, v40 row_ror:4 row_mask:0xf bank_mask:0xf
  s_nop 1
  v_add_f32_dpp v40, v40, v40 row_ror:8 row_mask:0xf bank_mask:0xf
  v_cvt_pk_bf16_f32 v40, 0, v40
  v_mul_f32 v40, v40, v32
  v_cvt_pk_bf16_f32 v40, 0, v40
  s_nop 0
  v_readlane_b32 s50, v40, 0
  v_readlane_b32 s51, v40, 32
  v_readlane_b32 s52, v40, 1
  v_readlane_b32 s53, v40, 33
  v_pk_add_f32 v[116:117], v[116:117], s[50:51]
  s_nop 0
  v_pk_add_f32 v[118:119], v[118:119], s[52:53]
  v_cvt_pk_bf16_f32 v116, 0, v116
  v_cvt_pk_bf16_f32 v117, 0, v117
  v_cvt_pk_bf16_f32 v118, 0, v118
  v_cvt_pk_bf16_f32 v119, 0, v119
  s_mov_b32 s96, 0xbfb8aa3b
  v_pk_mul_f32 v[120:121], v[116:117], s[96:97] op_sel_hi:[1,0]
  v_pk_mul_f32 v[122:123], v[118:119], s[96:97] op_sel_hi:[1,0]
  v_exp_f32 v120, v120
  v_exp_f32 v121, v121
  v_exp_f32 v122, v122
  v_exp_f32 v123, v123
  v_pk_add_f32 v[120:121], v[120:121], 1.0 op_sel_hi:[1,0]
  v_pk_add_f32 v[122:123], v[122:123], 1.0 op_sel_hi:[1,0]
  v_rcp_f32 v120, v120
  v_rcp_f32 v121, v121
  v_rcp_f32 v122, v122
  v_rcp_f32 v123, v123
  v_pk_mul_f32 v[120:121], v[120:121], v[116:117]
  v_pk_mul_f32 v[122:123], v[122:123], v[118:119]
  v_cvt_pk_bf16_f32 v120, 0, v120
  v_cvt_pk_bf16_f32 v121, 0, v121
  v_cvt_pk_bf16_f32 v122, 0, v122
  v_cvt_pk_bf16_f32 v123, 0, v123
  v_cndmask_b32 v108, v108, v120, s[6:7]
  v_cndmask_b32 v110, v110, v121, s[6:7]
  v_cndmask_b32 v112, v112, v122, s[6:7]
  v_cndmask_b32 v114, v114, v123, s[6:7]
  v_cndmask_b32 v109, v109, v120, s[8:9]
  v_cndmask_b32 v111, v111, v121, s[8:9]
  v_cndmask_b32 v113, v113, v122, s[8:9]
  v_cndmask_b32 v115, v115, v123, s[8:9]
L_NOWN1:
  s_mov_b32 s62, 65536
L_EX1:
  ds_read_b32 v7, v27 offset:64
  s_waitcnt lgkmcnt(0)
  v_cmp_ne_u32 vcc, 4, v7
  s_cbranch_vccz L_EX1_OK
  s_sub_u32 s62, s62, 1
  s_cbranch_scc0 L_EX1
L_EX1_OK:
  ds_read_b64 v[32:33], v6 offset:8192
  ds_read_b64 v[34:35], v6 offset:9216
  ds_read_b64 v[36:37], v6 offset:10240
  ds_read_b64 v[38:39], v6 offset:11264
  s_waitcnt lgkmcnt(3)
  v_cvt_pk_bf16_f32 v32, 0, v32
  v_cvt_pk_bf16_f32 v33, 0, v33
  s_waitcnt lgkmcnt(2)
  v_cvt_pk_bf16_f32 v34, 0, v34
  v_cvt_pk_bf16_f32 v35, 0, v35
  s_waitcnt lgkmcnt(1)
  v_cvt_pk_bf16_f32 v36, 0, v36
  v_cvt_pk_bf16_f32 v37, 0, v37
  s_waitcnt lgkmcnt(0)
  v_cvt_pk_bf16_f32 v38, 0, v38
  v_cvt_pk_bf16_f32 v39, 0, v39
  v_pk_fma_f32 v[32:33], v[32:33], v[2:3], v[92:93] op_sel_hi:[1,0,1]
  v_pk_fma_f32 v[34:35], v[34:35], v[2:3], v[94:95] op_sel:[0,1,0] op_sel_hi:[1,1,1]
  v_pk_fma_f32 v[36:37], v[36:37], v[4:5], v[96:97] op_sel_hi:[1,0,1]
  v_pk_fma_f32 v[38:39], v[38:39], v[4:5], v[98:99] op_sel:[0,1,0] op_sel_hi:[1,1,1]
  v_cvt_pk_bf16_f32 v92, 0, v32
  v_cvt_pk_bf16_f32 v93, 0, v33
  v_cvt_pk_bf16_f32 v94, 0, v34
  v_cvt_pk_bf16_f32 v95, 0, v35
  v_cvt_pk_bf16_f32 v96, 0, v36
  v_cvt_pk_bf16_f32 v97, 0, v37
  v_cvt_pk_bf16_f32 v98, 0, v38
  v_cvt_pk_bf16_f32 v99, 0, v39
  v_pk_mul_f32 v[32:33], v[92:93], v[108:109]
  v_pk_mul_f32 v[34:35], v[94:95], v[110:111]
  v_pk_mul_f32 v[36:37], v[96:97], v[112:113]
  v_pk_mul_f32 v[38:39], v[98:99], v[114:115]
  v_cvt_pk_bf16_f32 v32, 0, v32
  v_cvt_pk_bf16_f32 v33, 0, v33
  v_cvt_pk_bf16_f32 v34, 0, v34
  v_cvt_pk_bf16_f32 v35, 0, v35
  v_cvt_pk_bf16_f32 v36, 0, v36
  v_cvt_pk_bf16_f32 v37, 0, v37
  v_cvt_pk_bf16_f32 v38, 0, v38
  v_cvt_pk_bf16_f32 v39, 0, v39
  v_pk_add_f32 v[32:33], v[32:33], v[52:53]
  v_pk_add_f32 v[34:35], v[34:35], v[54:55]
  v_pk_add_f32 v[36:37], v[36:37], v[56:57]
  v_pk_add_f32 v[38:39], v[38:39], v[58:59]
  v_cvt_pk_bf16_f32 v108, v32, v34
  v_cvt_pk_bf16_f32 v109, v36, v38
  global_store_dwordx2 v29, v[108:109], s[28:29] offset:0
  v_cvt_pk_bf16_f32 v110, v33, v35
  v_cvt_pk_bf16_f32 v111, v37, v39
  global_store_dwordx2 v29, v[110:111], s[28:29] offset:1024
  s_branch L_FIN
L_KROLE:
  v_lshrrev_b32 v3, 4, v24
  s_and_b32 s70, s2, 7
  s_lshl_b32 s70, s70, 7
  v_lshl_add_u32 v3, v3, 10, s70
  v_and_b32 v4, 3, v24
  v_lshl_add_u32 v3, v4, 5, v3
  v_min_u32 v3, 2748, v3
  v_bfe_u32 v4, v24, 2, 2
  s_lshl_b32 s70, s44, 2
  s_add_u32 s70, s70, s41
  s_lshl_b32 s70, s70, 2
  v_add_u32 v4, s70, v4
  s_movk_i32 s70, 2752
  v_mad_u32_u24 v2, v4, s70, v3
  global_load_dword v6, v2, s[22:23]
  global_load_dword v7, v2, s[24:25]
  v_and_b32 v5, 15, v24
  v_lshrrev_b32 v9, 4, v24
  s_mul_i32 s71, s41, 27984
  v_and_b32 v3, 31, v24
  v_lshrrev_b32 v4, 5, v24
  v_mul_u32_u24 v18, 528, v3
  v_lshl_add_u32 v18, v4, 4, v18
  v_add_u32 v18, s71, v18
  v_lshlrev_b32 v19, 5, v3
  v_lshl_add_u32 v19, v4, 4, v19
  v_add_u32 v19, s71, v19
  v_lshl_add_u32 v20, v24, 5, s71
  v_lshlrev_b32 v21, 1, v3
  v_lshl_add_u32 v21, v4, 8, v21
  v_add_u32 v21, s71, v21
  v_add_u32 v22, s71, v25
  v_lshlrev_b32 v3, 3, v9
  v_sub_u32 v3, v5, v3
  s_add_u32 s53, s71, 96
  v_lshl_add_u32 v27, v3, 2, s53
  v_add_u32 v28, 1024, v27
  v_add_u32 v29, 2048, v27
  v_add_u32 v30, 3072, v27
  v_add_u32 v31, 4096, v27
  v_sub_u32 v4, 15, v3
  s_mov_b32 s54, 0xff800000
  s_mov_b32 s55, 0
  v_lshrrev_b64 v[46:47], v4, s[54:55]
  v_and_b32 v46, 0xff, v46
  v_lshl_or_b32 v46, v46, 15, v46
  v_lshrrev_b32 v38, 0, v46
  v_and_b32 v38, 0x10001, v38
  v_mul_u32_u24 v38, 0x3c00, v38
  v_lshrrev_b32 v39, 2, v46
  v_and_b32 v39, 0x10001, v39
  v_mul_u32_u24 v39, 0x3c00, v39
  v_lshrrev_b32 v40, 4, v46
  v_and_b32 v40, 0x10001, v40
  v_mul_u32_u24 v40, 0x3c00, v40
  v_lshrrev_b32 v41, 6, v46
  v_and_b32 v41, 0x10001, v41
  v_mul_u32_u24 v41, 0x3c00, v41
  s_mov_b32 s54, 0x7f0000
  s_mov_b32 s55, 0
  v_lshrrev_b64 v[46:47], v4, s[54:55]
  v_and_b32 v46, 0xff, v46
  v_lshl_or_b32 v46, v46, 15, v46
  v_lshrrev_b32 v42, 0, v46
  v_and_b32 v42, 0x10001, v42
  v_mul_u32_u24 v42, 0x3c00, v42
  v_lshrrev_b32 v43, 2, v46
  v_and_b32 v43, 0x10001, v43
  v_mul_u32_u24 v43, 0x3c00, v43
  v_lshrrev_b32 v44, 4, v46
  v_and_b32 v44, 0x10001, v44
  v_mul_u32_u24 v44, 0x3c00, v44
  v_lshrrev_b32 v45, 6, v46
  v_and_b32 v45, 0x10001, v45
  v_mul_u32_u24 v45, 0x3c00, v45
  v_lshlrev_b32 v3, 2, v9
  v_sub_u32 v3, v5, v3
  s_add_u32 s53, s71, 4336
  v_lshl_add_u32 v32, v3, 2, s53
  s_mul_i32 s53, s41, 4608
  s_add_u32 s53, s53, 111968
  v_lshl_add_u32 v3, v9, 4, s53
  v_lshl_add_u32 v33, v5, 5, v3
  v_xor_b32 v34, 3, v5
  v_lshl_add_u32 v34, v34, 5, v3
  v_add_u32 v34, 424, v34
  s_lshl_b32 s53, s41, 10
  v_lshl_add_u32 v3, v9, 4, s53
  v_lshl_add_u32 v35, v5, 6, v3
  v_mov_b32 v36, 163136
  v_mov_b32 v23, 0x0c0c0c0c
  s_mov_b64 exec, 0x1fff
  v_mov_b32 v23, 0x3020c0c
  s_mov_b64 exec, 0xfff
  v_mov_b32 v23, 0x3020302
  s_mov_b64 exec, 0x3f
  v_mov_b32 v23, 0x1000302
  s_mov_b64 exec, 0x1f
  v_mov_b32 v23, 0x1000100
  s_mov_b64 exec, -1
  s_mov_b32 s50, 0x3fb8aa3b
  s_mov_b32 s52, 0xbfb8aa3b
  s_mov_b32 s54, 0x3e22f983
  s_mov_b32 s56, 0x41000000
  s_mov_b32 s58, 0x43800000
  v_lshl_add_u32 v37, v24, 3, s71
  s_lshl_b32 s96, s41, 4
  s_waitcnt lgkmcnt(0)
  s_lshr_b64 s[98:99], s[34:35], s96
  s_lshl_b32 s98, s98, 16
  v_mov_b32 v118, s98
  v_mul_f32 v118, 0x3fb8aa3b, v118
  v_exp_f32 v118, v118
  v_mov_b32 v114, 0x3c00
  v_mov_b32 v115, 0x3c00
  ds_write_b64 v37, v[114:115]
  v_cvt_pk_bf16_f32 v118, 0, v118
  s_waitcnt vmcnt(5)
  v_lshlrev_b32 v110, 16, v14
  v_and_b32 v111, 0xffff0000, v14
  v_pk_mul_f32 v[110:111], v[110:111], s[50:51] op_sel_hi:[1,0]
  s_waitcnt vmcnt(4)
  v_lshlrev_b32 v112, 16, v15
  v_and_b32 v113, 0xffff0000, v15
  v_exp_f32 v110, v110
  v_exp_f32 v111, v111
  v_pk_mul_f32 v[112:113], v[112:113], v[118:119] op_sel_hi:[1,0]
  v_pk_mul_f32 v[112:113], v[112:113], s[54:55] op_sel_hi:[1,0]
  v_cvt_pk_bf16_f32 v110, 0, v110
  v_cvt_pk_bf16_f32 v111, 0, v111
  v_pk_mul_f32 v[110:111], v[110:111], v[118:119] op_sel_hi:[1,0]
  v_pk_mul_f32 v[110:111], v[110:111], s[52:53] op_sel_hi:[1,0]
  v_pk_mul_f32 v[116:117], v[112:113], s[56:57] op_sel_hi:[1,0]
  v_pk_mul_f32 v[114:115], v[110:111], s[56:57] op_sel_hi:[1,0]
  v_fract_f32 v116, v116
  v_fract_f32 v117, v117
  v_exp_f32 v114, v114
  v_exp_f32 v115, v115
  v_cos_f32 v128, v116
  v_sin_f32 v129, v116
  v_cos_f32 v130, v117
  v_sin_f32 v131, v117
  v_pk_mul_f32 v[128:129], v[128:129], v[114:115] op_sel_hi:[1,0]
  v_pk_mul_f32 v[130:131], v[130:131], v[114:115] op_sel:[0,1] op_sel_hi:[1,1]
  v_cvt_pk_f16_f32 v140, v128, v129
  v_cvt_pk_f16_f32 v141, v130, v131
  ds_write_b64 v37, v[140:141] offset:528
  v_pk_mul_f32 v[136:137], v[128:129], v[128:129] op_sel_hi:[1,0]
  v_pk_fma_f32 v[136:137], v[128:129], v[128:129], v[136:137] op_sel:[1,1,0] op_sel_hi:[0,1,1] neg_lo:[1,0,0]
  v_pk_mul_f32 v[138:139], v[130:131], v[130:131] op_sel_hi:[1,0]
  v_pk_fma_f32 v[138:139], v[130:131], v[130:131], v[138:139] op_sel:[1,1,0] op_sel_hi:[0,1,1] neg_lo:[1,0,0]
  v_cvt_pk_f16_f32 v142, v136, v137
  v_cvt_pk_f16_f32 v143, v138, v139
  ds_write_b64 v37, v[142:143] offset:1056
  v_pk_mul_f32 v[160:161], v[128:129], v[136:137] op_sel_hi:[1,0]
  v_pk_fma_f32 v[160:161], v[128:129], v[136:137], v[160:161] op_sel:[1,1,0] op_sel_hi:[0,1,1] neg_lo:[1,0,0]
  v_pk_mul_f32 v[162:163], v[130:131], v[138:139] op_sel_hi:[1,0]
  v_pk_fma_f32 v[162:163], v[130:131], v[138:139], v[162:163] op_sel:[1,1,0] op_sel_hi:[0,1,1] neg_lo:[1,0,0]
  v_cvt_pk_f16_f32 v144, v160, v161
  v_cvt_pk_f16_f32 v145, v162, v163
  ds_write_b64 v37, v[144:145] offset:1584
  v_pk_mul_f32 v[148:149], v[136:137], v[136:137] op_sel_hi:[1,0]
  v_pk_fma_f32 v[148:149], v[136:137], v[136:137], v[148:149] op_sel:[1,1,0] op_sel_hi:[0,1,1] neg_lo:[1,0,0]
  v_pk_mul_f32 v[150:151], v[138:139], v[138:139] op_sel_hi:[1,0]
  v_pk_fma_f32 v[150:151], v[138:139], v[138:139], v[150:151] op_sel:[1,1,0] op_sel_hi:[0,1,1] neg_lo:[1,0,0]
  v_cvt_pk_f16_f32 v146, v148, v149
  v_cvt_pk_f16_f32 v147, v150, v151
  ds_write_b64 v37, v[146:147] offset:2112
  s_waitcnt vmcnt(3)
  v_and_b32 v5, 0x7fff7fff, v16
  s_waitcnt vmcnt(2)
  v_and_b32 v9, 0x7fff7fff, v17
  v_pk_max_u16 v5, v5, v9
  v_lshlrev_b32 v9, 16, v5
  v_max_u32 v5, v5, v9
  v_pk_mul_f32 v[156:157], v[160:161], v[136:137] op_sel_hi:[1,0]
  v_pk_fma_f32 v[156:157], v[160:161], v[136:137], v[156:157] op_sel:[1,1,0] op_sel_hi:[0,1,1] neg_lo:[1,0,0]
  v_pk_mul_f32 v[158:159], v[162:163], v[138:139] op_sel_hi:[1,0]
  v_pk_fma_f32 v[158:159], v[162:163], v[138:139], v[158:159] op_sel:[1,1,0] op_sel_hi:[0,1,1] neg_lo:[1,0,0]
  v_cvt_pk_f16_f32 v140, v156, v157
  v_cvt_pk_f16_f32 v141, v158, v159
  ds_write_b64 v37, v[140:141] offset:2640
  v_pk_mul_f32 v[152:153], v[148:149], v[136:137] op_sel_hi:[1,0]
  v_pk_fma_f32 v[152:153], v[148:149], v[136:137], v[152:153] op_sel:[1,1,0] op_sel_hi:[0,1,1] neg_lo:[1,0,0]
  v_pk_mul_f32 v[154:155], v[150:151], v[138:139] op_sel_hi:[1,0]
  v_pk_fma_f32 v[154:155], v[150:151], v[138:139], v[154:155] op_sel:[1,1,0] op_sel_hi:[0,1,1] neg_lo:[1,0,0]
  v_cvt_pk_f16_f32 v142, v152, v153
  v_cvt_pk_f16_f32 v143, v154, v155
  ds_write_b64 v37, v[142:143] offset:3168
  v_pk_mul_f32 v[160:161], v[156:157], v[136:137] op_sel_hi:[1,0]
  v_pk_fma_f32 v[160:161], v[156:157], v[136:137], v[160:161] op_sel:[1,1,0] op_sel_hi:[0,1,1] neg_lo:[1,0,0]
  v_pk_mul_f32 v[162:163], v[158:159], v[138:139] op_sel_hi:[1,0]
  v_pk_fma_f32 v[162:163], v[158:159], v[138:139], v[162:163] op_sel:[1,1,0] op_sel_hi:[0,1,1] neg_lo:[1,0,0]
  v_cvt_pk_f16_f32 v144, v160, v161
  v_cvt_pk_f16_f32 v145, v162, v163
  ds_write_b64 v37, v[144:145] offset:3696
  v_pk_mul_f32 v[148:149], v[152:153], v[136:137] op_sel_hi:[1,0]
  v_pk_fma_f32 v[148:149], v[152:153], v[136:137], v[148:149] op_sel:[1,1,0] op_sel_hi:[0,1,1] neg_lo:[1,0,0]
  v_pk_mul_f32 v[150:151], v[154:155], v[138:139] op_sel_hi:[1,0]
  v_pk_fma_f32 v[150:151], v[154:155], v[138:139], v[150:151] op_sel:[1,1,0] op_sel_hi:[0,1,1] neg_lo:[1,0,0]
  v_cvt_pk_f16_f32 v146, v148, v149
  v_cvt_pk_f16_f32 v147, v150, v151
  ds_write_b64 v37, v[146:147] offset:4224
  v_max_u32_dpp v5, v5, v5 row_shr:1 row_mask:0xf bank_mask:0xf
  v_pk_mul_f32 v[156:157], v[160:161], v[136:137] op_sel_hi:[1,0]
  v_pk_fma_f32 v[156:157], v[160:161], v[136:137], v[156:157] op_sel:[1,1,0] op_sel_hi:[0,1,1] neg_lo:[1,0,0]
  v_max_u32_dpp v5, v5, v5 row_shr:2 row_mask:0xf bank_mask:0xf
  v_pk_mul_f32 v[158:159], v[162:163], v[138:139] op_sel_hi:[1,0]
  v_pk_fma_f32 v[158:159], v[162:163], v[138:139], v[158:159] op_sel:[1,1,0] op_sel_hi:[0,1,1] neg_lo:[1,0,0]
  v_max_u32_dpp v5, v5, v5 row_shr:4 row_mask:0xf bank_mask:0xf
  v_cvt_pk_f16_f32 v140, v156, v157
  v_cvt_pk_f16_f32 v141, v158, v159
  v_max_u32_dpp v5, v5, v5 row_shr:8 row_mask:0xf bank_mask:0xf
  ds_write_b64 v37, v[140:141] offset:4752
  v_pk_mul_f32 v[152:153], v[148:149], v[136:137] op_sel_hi:[1,0]
  v_max_u32_dpp v5, v5, v5 row_bcast:15 row_mask:0xa bank_mask:0xf
  v_pk_fma_f32 v[152:153], v[148:149], v[136:137], v[152:153] op_sel:[1,1,0] op_sel_hi:[0,1,1] neg_lo:[1,0,0]
  v_pk_mul_f32 v[154:155], v[150:151], v[138:139] op_sel_hi:[1,0]
  v_max_u32_dpp v5, v5, v5 row_bcast:31 row_mask:0xc bank_mask:0xf
  v_pk_fma_f32 v[154:155], v[150:151], v[138:139], v[154:155] op_sel:[1,1,0] op_sel_hi:[0,1,1] neg_lo:[1,0,0]
  v_cvt_pk_f16_f32 v142, v152, v153
  v_cvt_pk_f16_f32 v143, v154, v155
  ds_write_b64 v37, v[142:143] offset:5280
  v_pk_mul_f32 v[160:161], v[156:157], v[136:137] op_sel_hi:[1,0]
  v_pk_fma_f32 v[160:161], v[156:157], v[136:137], v[160:161] op_sel:[1,1,0] op_sel_hi:[0,1,1] neg_lo:[1,0,0]
  v_pk_mul_f32 v[162:163], v[158:159], v[138:139] op_sel_hi:[1,0]
  v_pk_fma_f32 v[162:163], v[158:159], v[138:139], v[162:163] op_sel:[1,1,0] op_sel_hi:[0,1,1] neg_lo:[1,0,0]
  v_cvt_pk_f16_f32 v144, v160, v161
  v_cvt_pk_f16_f32 v145, v162, v163
  ds_write_b64 v37, v[144:145] offset:5808
  v_pk_mul_f32 v[148:149], v[152:153], v[136:137] op_sel_hi:[1,0]
  v_pk_fma_f32 v[148:149], v[152:153], v[136:137], v[148:149] op_sel:[1,1,0] op_sel_hi:[0,1,1] neg_lo:[1,0,0]
  v_pk_mul_f32 v[150:151], v[154:155], v[138:139] op_sel_hi:[1,0]
  v_pk_fma_f32 v[150:151], v[154:155], v[138:139], v[150:151] op_sel:[1,1,0] op_sel_hi:[0,1,1] neg_lo:[1,0,0]
  v_cvt_pk_f16_f32 v146, v148, v149
  v_cvt_pk_f16_f32 v147, v150, v151
  ds_write_b64 v37, v[146:147] offset:6336
  v_and_b32 v5, 0xffff0000, v5
  v_mul_f32 v5, v5, v118
  v_lshlrev_b32 v120, 16, v16
  v_readlane_b32 s96, v5, 63
  v_lshlrev_b32 v121, 16, v17
  v_and_b32 v122, 0xffff0000, v16
  v_and_b32 v123, 0xffff0000, v17
  s_lshr_b32 s96, s96, 23
  s_max_u32 s96, s96, 10
  s_min_u32 s96, s96, 254
  s_sub_u32 s98, 261, s96
  s_lshl_b32 s98, s98, 23
  s_sub_u32 s97, s96, 6
  s_lshl_b32 s97, s97, 23
  v_pk_mul_f32 v[120:121], v[120:121], v[118:119] op_sel_hi:[1,0]
  v_pk_mul_f32 v[122:123], v[122:123], v[118:119] op_sel_hi:[1,0]
  v_pk_mul_f32 v[156:157], v[160:161], v[136:137] op_sel_hi:[1,0]
  v_pk_fma_f32 v[156:157], v[160:161], v[136:137], v[156:157] op_sel:[1,1,0] op_sel_hi:[0,1,1] neg_lo:[1,0,0]
  v_pk_mul_f32 v[158:159], v[162:163], v[138:139] op_sel_hi:[1,0]
  v_pk_fma_f32 v[158:159], v[162:163], v[138:139], v[158:159] op_sel:[1,1,0] op_sel_hi:[0,1,1] neg_lo:[1,0,0]
  v_cvt_pk_f16_f32 v140, v156, v157
  v_cvt_pk_f16_f32 v141, v158, v159
  ds_write_b64 v37, v[140:141] offset:6864
  v_pk_mul_f32 v[152:153], v[148:149], v[136:137] op_sel_hi:[1,0]
  v_pk_fma_f32 v[152:153], v[148:149], v[136:137], v[152:153] op_sel:[1,1,0] op_sel_hi:[0,1,1] neg_lo:[1,0,0]
  v_pk_mul_f32 v[154:155], v[150:151], v[138:139] op_sel_hi:[1,0]
  v_pk_fma_f32 v[154:155], v[150:151], v[138:139], v[154:155] op_sel:[1,1,0] op_sel_hi:[0,1,1] neg_lo:[1,0,0]
  v_cvt_pk_f16_f32 v142, v152, v153
  v_cvt_pk_f16_f32 v143, v154, v155
  ds_write_b64 v37, v[142:143] offset:7392
  v_pk_mul_f32 v[160:161], v[156:157], v[136:137] op_sel_hi:[1,0]
  v_pk_fma_f32 v[160:161], v[156:157], v[136:137], v[160:161] op_sel:[1,1,0] op_sel_hi:[0,1,1] neg_lo:[1,0,0]
  v_pk_mul_f32 v[162:163], v[158:159], v[138:139] op_sel_hi:[1,0]
  v_pk_fma_f32 v[162:163], v[158:159], v[138:139], v[162:163] op_sel:[1,1,0] op_sel_hi:[0,1,1] neg_lo:[1,0,0]
  v_cvt_pk_f16_f32 v144, v160, v161
  v_cvt_pk_f16_f32 v145, v162, v163
  ds_write_b64 v37, v[144:145] offset:7920
  v_pk_mul_f32 v[148:149], v[152:153], v[136:137] op_sel_hi:[1,0]
  v_pk_fma_f32 v[148:149], v[152:153], v[136:137], v[148:149] op_sel:[1,1,0] op_sel_hi:[0,1,1] neg_lo:[1,0,0]
  v_pk_mul_f32 v[150:151], v[154:155], v[138:139] op_sel_hi:[1,0]
  v_pk_fma_f32 v[150:151], v[154:155], v[138:139], v[150:151] op_sel:[1,1,0] op_sel_hi:[0,1,1] neg_lo:[1,0,0]
  v_cvt_pk_f16_f32 v146, v148, v149
  v_cvt_pk_f16_f32 v147, v150, v151
  ds_write_b64 v37, v[146:147] offset:8448
  v_exp_f32 v208, v110
  v_exp_f32 v209, v111
  v_fract_f32 v210, v112
  v_fract_f32 v211, v113
  v_cos_f32 v124, v210
  v_sin_f32 v125, v210
  v_cos_f32 v126, v211
  v_sin_f32 v127, v211
  v_pk_mul_f32 v[124:125], v[124:125], v[208:209] op_sel_hi:[1,0]
  v_pk_mul_f32 v[126:127], v[126:127], v[208:209] op_sel:[0,1] op_sel_hi:[1,1]
  v_pk_mul_f32 v[156:157], v[160:161], v[136:137] op_sel_hi:[1,0]
  v_pk_fma_f32 v[156:157], v[160:161], v[136:137], v[156:157] op_sel:[1,1,0] op_sel_hi:[0,1,1] neg_lo:[1,0,0]
  v_pk_mul_f32 v[158:159], v[162:163], v[138:139] op_sel_hi:[1,0]
  v_pk_fma_f32 v[158:159], v[162:163], v[138:139], v[158:159] op_sel:[1,1,0] op_sel_hi:[0,1,1] neg_lo:[1,0,0]
  v_cvt_pk_f16_f32 v140, v156, v157
  v_cvt_pk_f16_f32 v141, v158, v159
  ds_write_b64 v37, v[140:141] offset:8976
  v_pk_mul_f32 v[152:153], v[148:149], v[136:137] op_sel_hi:[1,0]
  v_pk_fma_f32 v[152:153], v[148:149], v[136:137], v[152:153] op_sel:[1,1,0] op_sel_hi:[0,1,1] neg_lo:[1,0,0]
  v_pk_mul_f32 v[154:155], v[150:151], v[138:139] op_sel_hi:[1,0]
  v_pk_fma_f32 v[154:155], v[150:151], v[138:139], v[154:155] op_sel:[1,1,0] op_sel_hi:[0,1,1] neg_lo:[1,0,0]
  v_cvt_pk_f16_f32 v142, v152, v153
  v_cvt_pk_f16_f32 v143, v154, v155
  ds_write_b64 v37, v[142:143] offset:9504
  v_pk_mul_f32 v[160:161], v[156:157], v[136:137] op_sel_hi:[1,0]
  v_pk_fma_f32 v[160:161], v[156:157], v[136:137], v[160:161] op_sel:[1,1,0] op_sel_hi:[0,1,1] neg_lo:[1,0,0]
  v_pk_mul_f32 v[162:163], v[158:159], v[138:139] op_sel_hi:[1,0]
  v_pk_fma_f32 v[162:163], v[158:159], v[138:139], v[162:163] op_sel:[1,1,0] op_sel_hi:[0,1,1] neg_lo:[1,0,0]
  v_cvt_pk_f16_f32 v144, v160, v161
  v_cvt_pk_f16_f32 v145, v162, v163
  ds_write_b64 v37, v[144:145] offset:10032
  v_pk_mul_f32 v[148:149], v[152:153], v[136:137] op_sel_hi:[1,0]
  v_pk_fma_f32 v[148:149], v[152:153], v[136:137], v[148:149] op_sel:[1,1,0] op_sel_hi:[0,1,1] neg_lo:[1,0,0]
  v_pk_mul_f32 v[150:151], v[154:155], v[138:139] op_sel_hi:[1,0]
  v_pk_fma_f32 v[150:151], v[154:155], v[138:139], v[150:151] op_sel:[1,1,0] op_sel_hi:[0,1,1] neg_lo:[1,0,0]
  v_cvt_pk_f16_f32 v146, v148, v149
  v_cvt_pk_f16_f32 v147, v150, v151
  ds_write_b64 v37, v[146:147] offset:10560
  v_pk_mul_f32 v[210:211], v[112:113], s[58:59] op_sel_hi:[1,0]
  v_pk_mul_f32 v[208:209], v[110:111], s[58:59] op_sel_hi:[1,0]
  v_fract_f32 v210, v210
  v_fract_f32 v211, v211
  v_exp_f32 v208, v208
  v_exp_f32 v209, v209
  v_cos_f32 v132, v210
  v_sin_f32 v133, v210
  v_cos_f32 v134, v211
  v_sin_f32 v135, v211
  v_pk_mul_f32 v[132:133], v[132:133], v[208:209] op_sel_hi:[1,0]
  v_pk_mul_f32 v[134:135], v[134:135], v[208:209] op_sel:[0,1] op_sel_hi:[1,1]
  v_pk_mul_f32 v[156:157], v[160:161], v[136:137] op_sel_hi:[1,0]
  v_pk_fma_f32 v[156:157], v[160:161], v[136:137], v[156:157] op_sel:[1,1,0] op_sel_hi:[0,1,1] neg_lo:[1,0,0]
  v_pk_mul_f32 v[158:159], v[162:163], v[138:139] op_sel_hi:[1,0]
  v_pk_fma_f32 v[158:159], v[162:163], v[138:139], v[158:159] op_sel:[1,1,0] op_sel_hi:[0,1,1] neg_lo:[1,0,0]
  v_cvt_pk_f16_f32 v140, v156, v157
  v_cvt_pk_f16_f32 v141, v158, v159
  ds_write_b64 v37, v[140:141] offset:11088
  v_pk_mul_f32 v[152:153], v[148:149], v[136:137] op_sel_hi:[1,0]
  v_pk_fma_f32 v[152:153], v[148:149], v[136:137], v[152:153] op_sel:[1,1,0] op_sel_hi:[0,1,1] neg_lo:[1,0,0]
  v_pk_mul_f32 v[154:155], v[150:151], v[138:139] op_sel_hi:[1,0]
  v_pk_fma_f32 v[154:155], v[150:151], v[138:139], v[154:155] op_sel:[1,1,0] op_sel_hi:[0,1,1] neg_lo:[1,0,0]
  v_cvt_pk_f16_f32 v142, v152, v153
  v_cvt_pk_f16_f32 v143, v154, v155
  ds_write_b64 v37, v[142:143] offset:11616
  v_pk_mul_f32 v[160:161], v[156:157], v[136:137] op_sel_hi:[1,0]
  v_pk_fma_f32 v[160:161], v[156:157], v[136:137], v[160:161] op_sel:[1,1,0] op_sel_hi:[0,1,1] neg_lo:[1,0,0]
  v_pk_mul_f32 v[162:163], v[158:159], v[138:139] op_sel_hi:[1,0]
  v_pk_fma_f32 v[162:163], v[158:159], v[138:139], v[162:163] op_sel:[1,1,0] op_sel_hi:[0,1,1] neg_lo:[1,0,0]
  v_cvt_pk_f16_f32 v144, v160, v161
  v_cvt_pk_f16_f32 v145, v162, v163
  ds_write_b64 v37, v[144:145] offset:12144
  v_pk_mul_f32 v[148:149], v[152:153], v[136:137] op_sel_hi:[1,0]
  v_pk_fma_f32 v[148:149], v[152:153], v[136:137], v[148:149] op_sel:[1,1,0] op_sel_hi:[0,1,1] neg_lo:[1,0,0]
  v_pk_mul_f32 v[150:151], v[154:155], v[138:139] op_sel_hi:[1,0]
  v_pk_fma_f32 v[150:151], v[154:155], v[138:139], v[150:151] op_sel:[1,1,0] op_sel_hi:[0,1,1] neg_lo:[1,0,0]
  v_cvt_pk_f16_f32 v146, v148, v149
  v_cvt_pk_f16_f32 v147, v150, v151
  ds_write_b64 v37, v[146:147] offset:12672
  v_pk_mul_f32 v[120:121], v[120:121], s[98:99] op_sel_hi:[1,0]
  v_pk_mul_f32 v[122:123], v[122:123], s[98:99] op_sel_hi:[1,0]
  s_lshl_b32 s96, s41, 2
  s_add_u32 s96, s96, 163264
  v_mov_b32 v9, s96
  v_mov_b32 v5, s97
  ds_write_b32 v9, v5
  v_pk_mul_f32 v[156:157], v[160:161], v[136:137] op_sel_hi:[1,0]
  v_pk_fma_f32 v[156:157], v[160:161], v[136:137], v[156:157] op_sel:[1,1,0] op_sel_hi:[0,1,1] neg_lo:[1,0,0]
  v_pk_mul_f32 v[158:159], v[162:163], v[138:139] op_sel_hi:[1,0]
  v_pk_fma_f32 v[158:159], v[162:163], v[138:139], v[158:159] op_sel:[1,1,0] op_sel_hi:[0,1,1] neg_lo:[1,0,0]
  v_cvt_pk_f16_f32 v140, v156, v157
  v_cvt_pk_f16_f32 v141, v158, v159
  ds_write_b64 v37, v[140:141] offset:13200
  v_pk_mul_f32 v[152:153], v[148:149], v[136:137] op_sel_hi:[1,0]
  v_pk_fma_f32 v[152:153], v[148:149], v[136:137], v[152:153] op_sel:[1,1,0] op_sel_hi:[0,1,1] neg_lo:[1,0,0]
  v_pk_mul_f32 v[154:155], v[150:151], v[138:139] op_sel_hi:[1,0]
  v_pk_fma_f32 v[154:155], v[150:151], v[138:139], v[154:155] op_sel:[1,1,0] op_sel_hi:[0,1,1] neg_lo:[1,0,0]
  v_cvt_pk_f16_f32 v142, v152, v153
  v_cvt_pk_f16_f32 v143, v154, v155
  ds_write_b64 v37, v[142:143] offset:13728
  v_pk_mul_f32 v[160:161], v[156:157], v[136:137] op_sel_hi:[1,0]
  v_pk_fma_f32 v[160:161], v[156:157], v[136:137], v[160:161] op_sel:[1,1,0] op_sel_hi:[0,1,1] neg_lo:[1,0,0]
  v_pk_mul_f32 v[162:163], v[158:159], v[138:139] op_sel_hi:[1,0]
  v_pk_fma_f32 v[162:163], v[158:159], v[138:139], v[162:163] op_sel:[1,1,0] op_sel_hi:[0,1,1] neg_lo:[1,0,0]
  v_cvt_pk_f16_f32 v144, v160, v161
  v_cvt_pk_f16_f32 v145, v162, v163
  ds_write_b64 v37, v[144:145] offset:14256
  v_pk_mul_f32 v[148:149], v[152:153], v[136:137] op_sel_hi:[1,0]
  v_pk_fma_f32 v[148:149], v[152:153], v[136:137], v[148:149] op_sel:[1,1,0] op_sel_hi:[0,1,1] neg_lo:[1,0,0]
  v_pk_mul_f32 v[150:151], v[154:155], v[138:139] op_sel_hi:[1,0]
  v_pk_fma_f32 v[150:151], v[154:155], v[138:139], v[150:151] op_sel:[1,1,0] op_sel_hi:[0,1,1] neg_lo:[1,0,0]
  v_cvt_pk_f16_f32 v146, v148, v149
  v_cvt_pk_f16_f32 v147, v150, v151
  ds_write_b64 v37, v[146:147] offset:14784
  v_pk_mul_f32 v[156:157], v[160:161], v[136:137] op_sel_hi:[1,0]
  v_pk_fma_f32 v[156:157], v[160:161], v[136:137], v[156:157] op_sel:[1,1,0] op_sel_hi:[0,1,1] neg_lo:[1,0,0]
  v_pk_mul_f32 v[158:159], v[162:163], v[138:139] op_sel_hi:[1,0]
  v_pk_fma_f32 v[158:159], v[162:163], v[138:139], v[158:159] op_sel:[1,1,0] op_sel_hi:[0,1,1] neg_lo:[1,0,0]
  v_cvt_pk_f16_f32 v140, v156, v157
  v_cvt_pk_f16_f32 v141, v158, v159
  ds_write_b64 v37, v[140:141] offset:15312
  v_pk_mul_f32 v[152:153], v[148:149], v[136:137] op_sel_hi:[1,0]
  v_pk_fma_f32 v[152:153], v[148:149], v[136:137], v[152:153] op_sel:[1,1,0] op_sel_hi:[0,1,1] neg_lo:[1,0,0]
  v_pk_mul_f32 v[154:155], v[150:151], v[138:139] op_sel_hi:[1,0]
  v_pk_fma_f32 v[154:155], v[150:151], v[138:139], v[154:155] op_sel:[1,1,0] op_sel_hi:[0,1,1] neg_lo:[1,0,0]
  v_cvt_pk_f16_f32 v142, v152, v153
  v_cvt_pk_f16_f32 v143, v154, v155
  ds_write_b64 v37, v[142:143] offset:15840
  v_pk_mul_f32 v[160:161], v[156:157], v[136:137] op_sel_hi:[1,0]
  v_pk_fma_f32 v[160:161], v[156:157], v[136:137], v[160:161] op_sel:[1,1,0] op_sel_hi:[0,1,1] neg_lo:[1,0,0]
  v_pk_mul_f32 v[162:163], v[158:159], v[138:139] op_sel_hi:[1,0]
  v_pk_fma_f32 v[162:163], v[158:159], v[138:139], v[162:163] op_sel:[1,1,0] op_sel_hi:[0,1,1] neg_lo:[1,0,0]
  v_cvt_pk_f16_f32 v144, v160, v161
  v_cvt_pk_f16_f32 v145, v162, v163
  ds_write_b64 v37, v[144:145] offset:16368
  v_cvt_pk_f16_f32 v146, v120, -v121
  v_cvt_pk_f16_f32 v147, v122, -v123
  ds_write_b64 v37, v[146:147] offset:16896
  ds_read_b128 v[46:49], v18 offset:0
  v_pk_mul_f32 v[164:165], v[120:121], v[124:125] op_sel_hi:[1,0]
  v_pk_fma_f32 v[164:165], v[120:121], v[124:125], v[164:165] op_sel:[1,1,0] op_sel_hi:[0,1,1] neg_lo:[1,0,0]
  v_pk_mul_f32 v[166:167], v[122:123], v[126:127] op_sel_hi:[1,0]
  v_pk_fma_f32 v[166:167], v[122:123], v[126:127], v[166:167] op_sel:[1,1,0] op_sel_hi:[0,1,1] neg_lo:[1,0,0]
  v_cvt_pk_f16_f32 v140, v164, -v165
  v_cvt_pk_f16_f32 v141, v166, -v167
  ds_write_b64 v37, v[140:141] offset:17424
  ds_read_b128 v[50:53], v18 offset:32
  v_pk_mul_f32 v[168:169], v[164:165], v[124:125] op_sel_hi:[1,0]
  v_pk_fma_f32 v[168:169], v[164:165], v[124:125], v[168:169] op_sel:[1,1,0] op_sel_hi:[0,1,1] neg_lo:[1,0,0]
  v_pk_mul_f32 v[170:171], v[166:167], v[126:127] op_sel_hi:[1,0]
  v_pk_fma_f32 v[170:171], v[166:167], v[126:127], v[170:171] op_sel:[1,1,0] op_sel_hi:[0,1,1] neg_lo:[1,0,0]
  v_cvt_pk_f16_f32 v142, v168, -v169
  v_cvt_pk_f16_f32 v143, v170, -v171
  ds_write_b64 v37, v[142:143] offset:17952
  ds_read_b128 v[54:57], v18 offset:64
  v_pk_mul_f32 v[172:173], v[168:169], v[124:125] op_sel_hi:[1,0]
  v_pk_fma_f32 v[172:173], v[168:169], v[124:125], v[172:173] op_sel:[1,1,0] op_sel_hi:[0,1,1] neg_lo:[1,0,0]
  v_pk_mul_f32 v[174:175], v[170:171], v[126:127] op_sel_hi:[1,0]
  v_pk_fma_f32 v[174:175], v[170:171], v[126:127], v[174:175] op_sel:[1,1,0] op_sel_hi:[0,1,1] neg_lo:[1,0,0]
  v_cvt_pk_f16_f32 v144, v172, -v173
  v_cvt_pk_f16_f32 v145, v174, -v175
  ds_write_b64 v37, v[144:145] offset:18480
  ds_read_b128 v[58:61], v18 offset:96
  v_pk_mul_f32 v[176:177], v[172:173], v[124:125] op_sel_hi:[1,0]
  v_pk_fma_f32 v[176:177], v[172:173], v[124:125], v[176:177] op_sel:[1,1,0] op_sel_hi:[0,1,1] neg_lo:[1,0,0]
  v_pk_mul_f32 v[178:179], v[174:175], v[126:127] op_sel_hi:[1,0]
  v_pk_fma_f32 v[178:179], v[174:175], v[126:127], v[178:179] op_sel:[1,1,0] op_sel_hi:[0,1,1] neg_lo:[1,0,0]
  v_cvt_pk_f16_f32 v146, v176, -v177
  v_cvt_pk_f16_f32 v147, v178, -v179
  ds_write_b64 v37, v[146:147] offset:19008
  ds_read_b128 v[62:65], v18 offset:128
  v_pk_mul_f32 v[180:181], v[176:177], v[124:125] op_sel_hi:[1,0]
  v_pk_fma_f32 v[180:181], v[176:177], v[124:125], v[180:181] op_sel:[1,1,0] op_sel_hi:[0,1,1] neg_lo:[1,0,0]
  v_pk_mul_f32 v[182:183], v[178:179], v[126:127] op_sel_hi:[1,0]
  v_pk_fma_f32 v[182:183], v[178:179], v[126:127], v[182:183] op_sel:[1,1,0] op_sel_hi:[0,1,1] neg_lo:[1,0,0]
  v_cvt_pk_f16_f32 v140, v180, -v181
  v_cvt_pk_f16_f32 v141, v182, -v183
  ds_write_b64 v37, v[140:141] offset:19536
  ds_read_b128 v[66:69], v18 offset:160
  v_pk_mul_f32 v[184:185], v[180:181], v[124:125] op_sel_hi:[1,0]
  v_pk_fma_f32 v[184:185], v[180:181], v[124:125], v[184:185] op_sel:[1,1,0] op_sel_hi:[0,1,1] neg_lo:[1,0,0]
  v_pk_mul_f32 v[186:187], v[182:183], v[126:127] op_sel_hi:[1,0]
  v_pk_fma_f32 v[186:187], v[182:183], v[126:127], v[186:187] op_sel:[1,1,0] op_sel_hi:[0,1,1] neg_lo:[1,0,0]
  v_cvt_pk_f16_f32 v142, v184, -v185
  v_cvt_pk_f16_f32 v143, v186, -v187
  ds_write_b64 v37, v[142:143] offset:20064
  ds_read_b128 v[70:73], v18 offset:192
  v_pk_mul_f32 v[188:189], v[184:185], v[124:125] op_sel_hi:[1,0]
  v_pk_fma_f32 v[188:189], v[184:185], v[124:125], v[188:189] op_sel:[1,1,0] op_sel_hi:[0,1,1] neg_lo:[1,0,0]
  v_pk_mul_f32 v[190:191], v[186:187], v[126:127] op_sel_hi:[1,0]
  v_pk_fma_f32 v[190:191], v[186:187], v[126:127], v[190:191] op_sel:[1,1,0] op_sel_hi:[0,1,1] neg_lo:[1,0,0]
  v_cvt_pk_f16_f32 v144, v188, -v189
  v_cvt_pk_f16_f32 v145, v190, -v191
  ds_write_b64 v37, v[144:145] offset:20592
  ds_read_b128 v[74:77], v18 offset:224
  v_pk_mul_f32 v[192:193], v[120:121], v[132:133] op_sel_hi:[1,0]
  v_pk_fma_f32 v[192:193], v[120:121], v[132:133], v[192:193] op_sel:[1,1,0] op_sel_hi:[0,1,1] neg_lo:[1,0,0]
  v_pk_mul_f32 v[194:195], v[122:123], v[134:135] op_sel_hi:[1,0]
  v_pk_fma_f32 v[194:195], v[122:123], v[134:135], v[194:195] op_sel:[1,1,0] op_sel_hi:[0,1,1] neg_lo:[1,0,0]
  v_cvt_pk_f16_f32 v146, v192, -v193
  v_cvt_pk_f16_f32 v147, v194, -v195
  ds_write_b64 v37, v[146:147] offset:21120
  ds_read_b128 v[78:81], v18 offset:256
  v_pk_mul_f32 v[196:197], v[176:177], v[132:133] op_sel_hi:[1,0]
  v_pk_fma_f32 v[196:197], v[176:177], v[132:133], v[196:197] op_sel:[1,1,0] op_sel_hi:[0,1,1] neg_lo:[1,0,0]
  v_pk_mul_f32 v[198:199], v[178:179], v[134:135] op_sel_hi:[1,0]
  v_pk_fma_f32 v[198:199], v[178:179], v[134:135], v[198:199] op_sel:[1,1,0] op_sel_hi:[0,1,1] neg_lo:[1,0,0]
  v_cvt_pk_f16_f32 v140, v196, -v197
  v_cvt_pk_f16_f32 v141, v198, -v199
  ds_write_b64 v37, v[140:141] offset:23232
  ds_read_b128 v[82:85], v18 offset:288
  v_pk_mul_f32 v[200:201], v[168:169], v[132:133] op_sel_hi:[1,0]
  v_pk_fma_f32 v[200:201], v[168:169], v[132:133], v[200:201] op_sel:[1,1,0] op_sel_hi:[0,1,1] neg_lo:[1,0,0]
  v_pk_mul_f32 v[202:203], v[170:171], v[134:135] op_sel_hi:[1,0]
  v_pk_fma_f32 v[202:203], v[170:171], v[134:135], v[202:203] op_sel:[1,1,0] op_sel_hi:[0,1,1] neg_lo:[1,0,0]
  v_cvt_pk_f16_f32 v142, v200, -v201
  v_cvt_pk_f16_f32 v143, v202, -v203
  ds_write_b64 v37, v[142:143] offset:21648
  ds_read_b128 v[86:89], v18 offset:320
  v_pk_mul_f32 v[204:205], v[184:185], v[132:133] op_sel_hi:[1,0]
  v_pk_fma_f32 v[204:205], v[184:185], v[132:133], v[204:205] op_sel:[1,1,0] op_sel_hi:[0,1,1] neg_lo:[1,0,0]
  v_pk_mul_f32 v[206:207], v[186:187], v[134:135] op_sel_hi:[1,0]
  v_pk_fma_f32 v[206:207], v[186:187], v[134:135], v[206:207] op_sel:[1,1,0] op_sel_hi:[0,1,1] neg_lo:[1,0,0]
  v_cvt_pk_f16_f32 v144, v204, -v205
  v_cvt_pk_f16_f32 v145, v206, -v207
  ds_write_b64 v37, v[144:145] offset:23760
  ds_read_b128 v[90:93], v18 offset:352
  v_pk_mul_f32 v[164:165], v[192:193], v[132:133] op_sel_hi:[1,0]
  v_pk_fma_f32 v[164:165], v[192:193], v[132:133], v[164:165] op_sel:[1,1,0] op_sel_hi:[0,1,1] neg_lo:[1,0,0]
  v_pk_mul_f32 v[166:167], v[194:195], v[134:135] op_sel_hi:[1,0]
  v_pk_fma_f32 v[166:167], v[194:195], v[134:135], v[166:167] op_sel:[1,1,0] op_sel_hi:[0,1,1] neg_lo:[1,0,0]
  v_cvt_pk_f16_f32 v146, v164, -v165
  v_cvt_pk_f16_f32 v147, v166, -v167
  ds_write_b64 v37, v[146:147] offset:22176
  ds_read_b128 v[94:97], v18 offset:384
  v_pk_mul_f32 v[172:173], v[196:197], v[132:133] op_sel_hi:[1,0]
  v_pk_fma_f32 v[172:173], v[196:197], v[132:133], v[172:173] op_sel:[1,1,0] op_sel_hi:[0,1,1] neg_lo:[1,0,0]
  v_pk_mul_f32 v[174:175], v[198:199], v[134:135] op_sel_hi:[1,0]
  v_pk_fma_f32 v[174:175], v[198:199], v[134:135], v[174:175] op_sel:[1,1,0] op_sel_hi:[0,1,1] neg_lo:[1,0,0]
  v_cvt_pk_f16_f32 v140, v172, -v173
  v_cvt_pk_f16_f32 v141, v174, -v175
  ds_write_b64 v37, v[140:141] offset:22704
  ds_read_b128 v[98:101], v18 offset:416
  v_pk_mul_f32 v[180:181], v[164:165], v[132:133] op_sel_hi:[1,0]
  v_pk_fma_f32 v[180:181], v[164:165], v[132:133], v[180:181] op_sel:[1,1,0] op_sel_hi:[0,1,1] neg_lo:[1,0,0]
  v_pk_mul_f32 v[182:183], v[166:167], v[134:135] op_sel_hi:[1,0]
  v_pk_fma_f32 v[182:183], v[166:167], v[134:135], v[182:183] op_sel:[1,1,0] op_sel_hi:[0,1,1] neg_lo:[1,0,0]
  v_cvt_pk_f16_f32 v142, v180, -v181
  v_cvt_pk_f16_f32 v143, v182, -v183
  ds_write_b64 v37, v[142:143] offset:24288
  ds_read_b128 v[102:105], v18 offset:448
  v_pk_mul_f32 v[188:189], v[172:173], v[132:133] op_sel_hi:[1,0]
  v_pk_fma_f32 v[188:189], v[172:173], v[132:133], v[188:189] op_sel:[1,1,0] op_sel_hi:[0,1,1] neg_lo:[1,0,0]
  v_pk_mul_f32 v[190:191], v[174:175], v[134:135] op_sel_hi:[1,0]
  v_pk_fma_f32 v[190:191], v[174:175], v[134:135], v[190:191] op_sel:[1,1,0] op_sel_hi:[0,1,1] neg_lo:[1,0,0]
  v_cvt_pk_f16_f32 v144, v188, -v189
  v_cvt_pk_f16_f32 v145, v190, -v191
  ds_write_b64 v37, v[144:145] offset:24816
  ds_read_b128 v[106:109], v18 offset:480
  v_pk_mul_f32 v[192:193], v[180:181], v[132:133] op_sel_hi:[1,0]
  v_pk_fma_f32 v[192:193], v[180:181], v[132:133], v[192:193] op_sel:[1,1,0] op_sel_hi:[0,1,1] neg_lo:[1,0,0]
  v_pk_mul_f32 v[194:195], v[182:183], v[134:135] op_sel_hi:[1,0]
  v_pk_fma_f32 v[194:195], v[182:183], v[134:135], v[194:195] op_sel:[1,1,0] op_sel_hi:[0,1,1] neg_lo:[1,0,0]
  v_cvt_pk_f16_f32 v146, v192, -v193
  v_cvt_pk_f16_f32 v147, v194, -v195
  ds_write_b64 v37, v[146:147] offset:25344
  v_pk_mul_f32 v[196:197], v[192:193], v[132:133] op_sel_hi:[1,0]
  v_pk_fma_f32 v[196:197], v[192:193], v[132:133], v[196:197] op_sel:[1,1,0] op_sel_hi:[0,1,1] neg_lo:[1,0,0]
  v_pk_mul_f32 v[198:199], v[194:195], v[134:135] op_sel_hi:[1,0]
  v_pk_fma_f32 v[198:199], v[194:195], v[134:135], v[198:199] op_sel:[1,1,0] op_sel_hi:[0,1,1] neg_lo:[1,0,0]
  v_cvt_pk_f16_f32 v140, v196, -v197
  v_cvt_pk_f16_f32 v141, v198, -v199
  ds_write_b64 v37, v[140:141] offset:25872
  v_pk_mul_f32 v[200:201], v[196:197], v[132:133] op_sel_hi:[1,0]
  v_pk_fma_f32 v[200:201], v[196:197], v[132:133], v[200:201] op_sel:[1,1,0] op_sel_hi:[0,1,1] neg_lo:[1,0,0]
  v_pk_mul_f32 v[202:203], v[198:199], v[134:135] op_sel_hi:[1,0]
  v_pk_fma_f32 v[202:203], v[198:199], v[134:135], v[202:203] op_sel:[1,1,0] op_sel_hi:[0,1,1] neg_lo:[1,0,0]
  v_cvt_pk_f16_f32 v142, v200, -v201
  v_cvt_pk_f16_f32 v143, v202, -v203
  ds_write_b64 v37, v[142:143] offset:26400
  v_pk_mul_f32 v[204:205], v[200:201], v[132:133] op_sel_hi:[1,0]
  v_pk_fma_f32 v[204:205], v[200:201], v[132:133], v[204:205] op_sel:[1,1,0] op_sel_hi:[0,1,1] neg_lo:[1,0,0]
  v_pk_mul_f32 v[206:207], v[202:203], v[134:135] op_sel_hi:[1,0]
  v_pk_fma_f32 v[206:207], v[202:203], v[134:135], v[206:207] op_sel:[1,1,0] op_sel_hi:[0,1,1] neg_lo:[1,0,0]
  v_cvt_pk_f16_f32 v144, v204, -v205
  v_cvt_pk_f16_f32 v145, v206, -v207
  ds_write_b64 v37, v[144:145] offset:26928
  v_pk_mul_f32 v[168:169], v[204:205], v[132:133] op_sel_hi:[1,0]
  v_pk_fma_f32 v[168:169], v[204:205], v[132:133], v[168:169] op_sel:[1,1,0] op_sel_hi:[0,1,1] neg_lo:[1,0,0]
  v_pk_mul_f32 v[170:171], v[206:207], v[134:135] op_sel_hi:[1,0]
  v_pk_fma_f32 v[170:171], v[206:207], v[134:135], v[170:171] op_sel:[1,1,0] op_sel_hi:[0,1,1] neg_lo:[1,0,0]
  v_cvt_pk_f16_f32 v146, v168, -v169
  v_cvt_pk_f16_f32 v147, v170, -v171
  ds_write_b64 v37, v[146:147] offset:27456
  ds_read_b128 v[10:13], v18 offset:16896
  ds_read_b128 v[14:17], v18 offset:16928
  ds_read_b128 v[110:113], v18 offset:16960
  ds_read_b128 v[114:117], v18 offset:16992
  ds_read_b128 v[118:121], v18 offset:17024
  ds_read_b128 v[122:125], v18 offset:17056
  ds_read_b128 v[126:129], v18 offset:17088
  ds_read_b128 v[130:133], v18 offset:17120
  ds_read_b128 v[134:137], v18 offset:17152
  ds_read_b128 v[138:141], v18 offset:17184
  ds_read_b128 v[142:145], v18 offset:17216
  ds_read_b128 v[146:149], v18 offset:17248
  ds_read_b128 v[150:153], v18 offset:17280
  ds_read_b128 v[154:157], v18 offset:17312
  ds_read_b128 v[158:161], v18 offset:17344
  ds_read_b128 v[162:165], v18 offset:17376
  v_mov_b32 v3, 0
  v_mov_b32 v4, 1
  s_mov_b64 exec, 0xffff
  ds_write_b32 v22, v3
  s_mov_b64 exec, 1
  ds_add_u32 v36, v4 offset:16
  s_mov_b64 exec, -1
  s_waitcnt lgkmcnt(15)
  v_mfma_f32_32x32x16_f16 v[170:185], v[10:13], v[46:49], 0
  v_mfma_f32_32x32x16_f16 v[170:185], v[14:17], v[50:53], v[170:185]
  v_mfma_f32_32x32x16_f16 v[170:185], v[110:113], v[54:57], v[170:185]
  s_waitcnt lgkmcnt(14)
  v_mfma_f32_32x32x16_f16 v[170:185], v[114:117], v[58:61], v[170:185]
  s_waitcnt lgkmcnt(13)
  v_mfma_f32_32x32x16_f16 v[170:185], v[118:121], v[62:65], v[170:185]
  s_waitcnt lgkmcnt(12)
  v_mfma_f32_32x32x16_f16 v[170:185], v[122:125], v[66:69], v[170:185]
  s_waitcnt lgkmcnt(11)
  v_mfma_f32_32x32x16_f16 v[170:185], v[126:129], v[70:73], v[170:185]
  s_waitcnt lgkmcnt(10)
  v_mfma_f32_32x32x16_f16 v[170:185], v[130:133], v[74:77], v[170:185]
  s_waitcnt lgkmcnt(9)
  v_mfma_f32_32x32x16_f16 v[170:185], v[134:137], v[78:81], v[170:185]
  s_waitcnt lgkmcnt(8)
  v_mfma_f32_32x32x16_f16 v[170:185], v[138:141], v[82:85], v[170:185]
  s_waitcnt lgkmcnt(7)
  v_mfma_f32_32x32x16_f16 v[170:185], v[142:145], v[86:89], v[170:185]
  s_waitcnt lgkmcnt(6)
  v_mfma_f32_32x32x16_f16 v[170:185], v[146:149], v[90:93], v[170:185]
  s_waitcnt lgkmcnt(5)
  v_mfma_f32_32x32x16_f16 v[170:185], v[150:153], v[94:97], v[170:185]
  s_waitcnt lgkmcnt(4)
  v_mfma_f32_32x32x16_f16 v[170:185], v[154:157], v[98:101], v[170:185]
  s_waitcnt lgkmcnt(3)
  v_mfma_f32_32x32x16_f16 v[170:185], v[158:161], v[102:105], v[170:185]
  s_waitcnt lgkmcnt(2)
  v_mfma_f32_32x32x16_f16 v[170:185], v[162:165], v[106:109], v[170:185]
  s_nop 11
  v_cvt_pk_f16_f32 v186, v174, v174
  v_cvt_pk_f16_f32 v187, v174, v174
  v_cvt_pk_f16_f32 v188, v175, v174
  v_cvt_pk_f16_f32 v189, v175, v175
  ds_write_b128 v19, v[186:189] offset:1088
  ds_write_b16 v19, v186 offset:1084
  v_cvt_pk_f16_f32 v190, v170, 0
  v_cvt_pk_f16_f32 v191, v171, v170
  v_cvt_pk_f16_f32 v192, v172, v171
  v_cvt_pk_f16_f32 v193, v173, v172
  ds_write_b128 v19, v[190:193] offset:64
  ds_write_b16 v19, v193 offset:82
  v_mov_b32_dpp v2, v178 wave_rol:1 row_mask:0xf bank_mask:0xf
  v_cvt_pk_f16_f32 v194, v176, v176
  v_cvt_pk_f16_f32 v195, v176, v176
  v_mov_b32_dpp v2, v176 wave_shl:1 row_mask:0xf bank_mask:0xf
  v_cvt_pk_f16_f32 v196, v176, v176
  v_cvt_pk_f16_f32 v197, v177, v176
  v_cvt_pk_f16_f32 v198, v177, v177
  v_cvt_pk_f16_f32 v199, v177, v177
  v_cvt_pk_f16_f32 v200, v2, v177
  v_cvt_pk_f16_f32 v201, v2, v2
  ds_write_b128 v20, v[194:197] offset:2112
  ds_write_b128 v20, v[198:201] offset:2128
  ds_write_b16 v20, v194 offset:2108
  v_cvt_pk_f16_f32 v202, v178, v179
  v_cvt_pk_f16_f32 v203, v180, v181
  v_readlane_b32 s50, v202, 0
  v_readlane_b32 s51, v202, 1
  s_pack_ll_b32_b16 s50, s50, s51
  v_perm_b32 v204, s50, s50, v23
  ds_write_b32 v22, v204 offset:4160
  s_mov_b64 exec, -4
  ds_write_b16 v21, v202 offset:4344
  s_mov_b64 exec, 0xffffffff
  ds_write_b16_d16_hi v21, v202 offset:4408
  ds_write_b16 v21, v203 offset:4472
  ds_write_b16_d16_hi v21, v203 offset:4536
  s_mov_b64 exec, -1
  ds_read2_b32 v[10:11], v27 offset0:8 offset1:6
  ds_read2_b32 v[12:13], v27 offset0:4 offset1:2
  ds_read2_b32 v[46:47], v27 offset0:40 offset1:38
  ds_read2_b32 v[48:49], v27 offset0:36 offset1:34
  ds_read2_b32 v[14:15], v27 offset0:72 offset1:70
  ds_read2_b32 v[16:17], v27 offset0:68 offset1:66
  ds_read2_b32 v[50:51], v27 offset0:104 offset1:102
  ds_read2_b32 v[52:53], v27 offset0:100 offset1:98
  ds_read2_b32 v[110:111], v27 offset0:136 offset1:134
  ds_read2_b32 v[112:113], v27 offset0:132 offset1:130
  ds_read2_b32 v[54:55], v27 offset0:168 offset1:166
  ds_read2_b32 v[56:57], v27 offset0:164 offset1:162
  ds_read2_b32 v[114:115], v27 offset0:200 offset1:198
  ds_read2_b32 v[116:117], v27 offset0:196 offset1:194
  ds_read2_b32 v[58:59], v27 offset0:232 offset1:230
  ds_read2_b32 v[60:61], v27 offset0:228 offset1:226
  ds_read2_b32 v[118:119], v28 offset0:8 offset1:6
  ds_read2_b32 v[120:121], v28 offset0:4 offset1:2
  ds_read2_b32 v[62:63], v28 offset0:40 offset1:38
  ds_read2_b32 v[64:65], v28 offset0:36 offset1:34
  ds_read2_b32 v[122:123], v28 offset0:72 offset1:70
  ds_read2_b32 v[124:125], v28 offset0:68 offset1:66
  ds_read2_b32 v[66:67], v28 offset0:104 offset1:102
  ds_read2_b32 v[68:69], v28 offset0:100 offset1:98
  ds_read2_b32 v[126:127], v28 offset0:136 offset1:134
  ds_read2_b32 v[128:129], v28 offset0:132 offset1:130
  ds_read2_b32 v[70:71], v28 offset0:168 offset1:166
  ds_read2_b32 v[72:73], v28 offset0:164 offset1:162
  ds_read2_b32 v[130:131], v28 offset0:200 offset1:198
  ds_read2_b32 v[132:133], v28 offset0:196 offset1:194
  ds_read2_b32 v[74:75], v28 offset0:232 offset1:230
  ds_read2_b32 v[76:77], v28 offset0:228 offset1:226
  ds_read2_b32 v[134:135], v29 offset0:8 offset1:6
  ds_read2_b32 v[136:137], v29 offset0:4 offset1:2
  ds_read2_b32 v[78:79], v29 offset0:40 offset1:38
  ds_read2_b32 v[80:81], v29 offset0:36 offset1:34
  ds_read2_b32 v[138:139], v29 offset0:72 offset1:70
  ds_read2_b32 v[140:141], v29 offset0:68 offset1:66
  ds_read2_b32 v[82:83], v29 offset0:104 offset1:102
  ds_read2_b32 v[84:85], v29 offset0:100 offset1:98
  ds_read2_b32 v[142:143], v29 offset0:136 offset1:134
  ds_read2_b32 v[144:145], v29 offset0:132 offset1:130
  ds_read2_b32 v[86:87], v29 offset0:168 offset1:166
  ds_read2_b32 v[88:89], v29 offset0:164 offset1:162
  ds_read2_b32 v[146:147], v29 offset0:200 offset1:198
  ds_read2_b32 v[148:149], v29 offset0:196 offset1:194
  ds_read2_b32 v[90:91], v29 offset0:232 offset1:230
  ds_read2_b32 v[92:93], v29 offset0:228 offset1:226
  ds_read2_b32 v[150:151], v30 offset0:8 offset1:6
  ds_read2_b32 v[152:153], v30 offset0:4 offset1:2
  ds_read2_b32 v[94:95], v30 offset0:40 offset1:38
  ds_read2_b32 v[96:97], v30 offset0:36 offset1:34
  ds_read2_b32 v[154:155], v30 offset0:72 offset1:70
  ds_read2_b32 v[156:157], v30 offset0:68 offset1:66
  ds_read2_b32 v[98:99], v30 offset0:104 offset1:102
  ds_read2_b32 v[100:101], v30 offset0:100 offset1:98
  ds_read2_b32 v[158:159], v30 offset0:136 offset1:134
  ds_read2_b32 v[160:161], v30 offset0:132 offset1:130
  ds_read2_b32 v[102:103], v30 offset0:168 offset1:166
  ds_read2_b32 v[104:105], v30 offset0:164 offset1:162
  ds_read2_b32 v[162:163], v30 offset0:200 offset1:198
  ds_read2_b32 v[164:165], v30 offset0:196 offset1:194
  ds_read2_b32 v[106:107], v30 offset0:232 offset1:230
  ds_read2_b32 v[108:109], v30 offset0:228 offset1:226
  ds_read2_b32 v[166:167], v31 offset0:8 offset1:6
  ds_read2_b32 v[168:169], v31 offset0:4 offset1:2
  ds_read2_b32 v[18:19], v32 offset0:0 offset1:1
  ds_read2_b32 v[20:21], v32 offset0:2 offset1:3
  ds_read2_b32 v[28:29], v32 offset0:16 offset1:17
  ds_read2_b32 v[30:31], v32 offset0:18 offset1:19
  ds_read2_b32 v[170:171], v32 offset0:32 offset1:33
  ds_read2_b32 v[172:173], v32 offset0:34 offset1:35
  ds_read2_b32 v[174:175], v32 offset0:48 offset1:49
  ds_read2_b32 v[176:177], v32 offset0:50 offset1:51
  s_waitcnt lgkmcnt(0)
  s_mov_b32 s62, 65536
L_B3:
  ds_read_b32 v3, v36 offset:16
  s_waitcnt lgkmcnt(0)
  v_cmp_gt_u32 vcc, 8, v3
  s_cbranch_vccz L_B3_OK
  s_sub_u32 s62, s62, 1
  s_cbranch_scc0 L_B3
L_B3_OK:
  s_cmp_eq_u32 s43, 0
  s_cbranch_scc0 L_CONV1
  ds_read_b128 v[194:197], v33 offset:448
  ds_read_b128 v[198:201], v33 offset:384
  ds_read_b128 v[202:205], v33 offset:320
  ds_read_b128 v[206:209], v33 offset:256
  ds_read_b128 v[210:213], v33 offset:192
  ds_read_b128 v[214:217], v33 offset:128
  ds_read_b128 v[218:221], v33 offset:64
  ds_read_b128 v[222:225], v33 offset:0
  v_mov_b32 v2, 1
  ds_read2_b64 v[226:229], v34 offset0:0 offset1:1
  ds_read2_b64 v[230:233], v34 offset0:64 offset1:65
  ds_read2_b64 v[234:237], v34 offset0:128 offset1:129
  ds_read2_b64 v[238:241], v34 offset0:192 offset1:193
  s_waitcnt lgkmcnt(11)
  v_mfma_f32_16x16x32_f16 v[178:181], v[10:13], v[194:197], 0
  v_mfma_f32_16x16x32_f16 v[182:185], v[150:153], v[194:197], 0
  v_mfma_f32_16x16x32_f16 v[186:189], v[166:169], v[194:197], 0
  ds_read_b128 v[194:197], v33 offset:960
  s_waitcnt lgkmcnt(11)
  v_mfma_f32_16x16x32_f16 v[178:181], v[46:49], v[198:201], v[178:181]
  v_mfma_f32_16x16x32_f16 v[182:185], v[94:97], v[198:201], v[182:185]
  ds_read_b128 v[198:201], v33 offset:896
  s_waitcnt lgkmcnt(11)
  v_mfma_f32_16x16x32_f16 v[178:181], v[14:17], v[202:205], v[178:181]
  v_mfma_f32_16x16x32_f16 v[182:185], v[154:157], v[202:205], v[182:185]
  ds_read_b128 v[202:205], v33 offset:832
  s_waitcnt lgkmcnt(11)
  v_mfma_f32_16x16x32_f16 v[178:181], v[50:53], v[206:209], v[178:181]
  v_mfma_f32_16x16x32_f16 v[182:185], v[98:101], v[206:209], v[182:185]
  ds_read_b128 v[206:209], v33 offset:768
  s_waitcnt lgkmcnt(11)
  v_mfma_f32_16x16x32_f16 v[178:181], v[110:113], v[210:213], v[178:181]
  v_mfma_f32_16x16x32_f16 v[182:185], v[158:161], v[210:213], v[182:185]
  ds_read_b128 v[210:213], v33 offset:704
  s_waitcnt lgkmcnt(11)
  v_mfma_f32_16x16x32_f16 v[178:181], v[54:57], v[214:217], v[178:181]
  v_mfma_f32_16x16x32_f16 v[182:185], v[102:105], v[214:217], v[182:185]
  ds_read_b128 v[214:217], v33 offset:640
  s_waitcnt lgkmcnt(11)
  v_mfma_f32_16x16x32_f16 v[178:181], v[114:117], v[218:221], v[178:181]
  v_mfma_f32_16x16x32_f16 v[182:185], v[162:165], v[218:221], v[182:185]
  ds_read_b128 v[218:221], v33 offset:576
  s_waitcnt lgkmcnt(11)
  v_mfma_f32_16x16x32_f16 v[178:181], v[58:61], v[222:225], v[178:181]
  v_mfma_f32_16x16x32_f16 v[182:185], v[106:109], v[222:225], v[182:185]
  ds_read_b128 v[222:225], v33 offset:512
  s_waitcnt lgkmcnt(7)
  v_mfma_f32_16x16x32_f16 v[182:185], v[134:137], v[194:197], v[182:185]
  v_mfma_f32_16x16x32_f16 v[186:189], v[150:153], v[194:197], v[186:189]
  ds_read_b128 v[194:197], v33 offset:1472
  s_waitcnt lgkmcnt(7)
  v_mfma_f32_16x16x32_f16 v[182:185], v[78:81], v[198:201], v[182:185]
  v_mfma_f32_16x16x32_f16 v[186:189], v[94:97], v[198:201], v[186:189]
  ds_read_b128 v[198:201], v33 offset:1408
  v_mfma_f32_16x16x32_f16 v[242:245], v[226:229], v[38:41], 0
  v_mfma_f32_16x16x32_f16 v[246:249], v[226:229], v[42:45], 0
  s_waitcnt lgkmcnt(7)
  v_mfma_f32_16x16x32_f16 v[182:185], v[138:141], v[202:205], v[182:185]
  v_mfma_f32_16x16x32_f16 v[186:189], v[154:157], v[202:205], v[186:189]
  ds_read_b128 v[202:205], v33 offset:1344
  ds_write_b128 v35, v[178:181] offset:8192
  s_mov_b64 exec, 1
  ds_add_u32 v36, v2 offset:32
  s_mov_b64 exec, -1
  s_waitcnt lgkmcnt(9)
  v_mfma_f32_16x16x32_f16 v[182:185], v[82:85], v[206:209], v[182:185]
  v_mfma_f32_16x16x32_f16 v[186:189], v[98:101], v[206:209], v[186:189]
  ds_read_b128 v[206:209], v33 offset:1280
  s_waitcnt lgkmcnt(9)
  v_mfma_f32_16x16x32_f16 v[182:185], v[142:145], v[210:213], v[182:185]
  v_mfma_f32_16x16x32_f16 v[186:189], v[158:161], v[210:213], v[186:189]
  ds_read_b128 v[210:213], v33 offset:1216
  v_cvt_pk_f16_f32 v226, v242, v246
  v_cvt_pk_f16_f32 v227, v243, v247
  v_cvt_pk_f16_f32 v228, v244, v248
  v_cvt_pk_f16_f32 v229, v245, v249
  s_waitcnt lgkmcnt(9)
  v_mfma_f32_16x16x32_f16 v[182:185], v[86:89], v[214:217], v[182:185]
  v_mfma_f32_16x16x32_f16 v[186:189], v[102:105], v[214:217], v[186:189]
  ds_read_b128 v[214:217], v33 offset:1152
  s_waitcnt lgkmcnt(9)
  v_mfma_f32_16x16x32_f16 v[182:185], v[146:149], v[218:221], v[182:185]
  v_mfma_f32_16x16x32_f16 v[186:189], v[162:165], v[218:221], v[186:189]
  ds_read_b128 v[218:221], v33 offset:1088
  v_mfma_f32_16x16x32_f16 v[186:189], v[226:229], v[18:21], v[186:189]
  v_mfma_f32_16x16x32_f16 v[190:193], v[226:229], v[174:177], 0
  s_waitcnt lgkmcnt(9)
  v_mfma_f32_16x16x32_f16 v[182:185], v[90:93], v[222:225], v[182:185]
  v_mfma_f32_16x16x32_f16 v[186:189], v[106:109], v[222:225], v[186:189]
  ds_read_b128 v[222:225], v33 offset:1024
  s_waitcnt lgkmcnt(9)
  v_mfma_f32_16x16x32_f16 v[182:185], v[118:121], v[194:197], v[182:185]
  v_mfma_f32_16x16x32_f16 v[186:189], v[134:137], v[194:197], v[186:189]
  ds_read_b128 v[194:197], v33 offset:1984
  s_waitcnt lgkmcnt(9)
  v_mfma_f32_16x16x32_f16 v[182:185], v[62:65], v[198:201], v[182:185]
  v_mfma_f32_16x16x32_f16 v[186:189], v[78:81], v[198:201], v[186:189]
  ds_read_b128 v[198:201], v33 offset:1920
  v_mfma_f32_16x16x32_f16 v[242:245], v[230:233], v[38:41], 0
  v_mfma_f32_16x16x32_f16 v[246:249], v[230:233], v[42:45], 0
  s_waitcnt lgkmcnt(9)
  v_mfma_f32_16x16x32_f16 v[182:185], v[122:125], v[202:205], v[182:185]
  v_mfma_f32_16x16x32_f16 v[186:189], v[138:141], v[202:205], v[186:189]
  ds_read_b128 v[202:205], v33 offset:1856
  s_waitcnt lgkmcnt(7)
  v_mfma_f32_16x16x32_f16 v[182:185], v[66:69], v[206:209], v[182:185]
  v_mfma_f32_16x16x32_f16 v[186:189], v[82:85], v[206:209], v[186:189]
  ds_read_b128 v[206:209], v33 offset:1792
  s_waitcnt lgkmcnt(7)
  v_mfma_f32_16x16x32_f16 v[182:185], v[126:129], v[210:213], v[182:185]
  v_mfma_f32_16x16x32_f16 v[186:189], v[142:145], v[210:213], v[186:189]
  ds_read_b128 v[210:213], v33 offset:1728
  v_cvt_pk_f16_f32 v230, v242, v246
  v_cvt_pk_f16_f32 v231, v243, v247
  v_cvt_pk_f16_f32 v232, v244, v248
  v_cvt_pk_f16_f32 v233, v245, v249
  s_waitcnt lgkmcnt(7)
  v_mfma_f32_16x16x32_f16 v[182:185], v[70:73], v[214:217], v[182:185]
  v_mfma_f32_16x16x32_f16 v[186:189], v[86:89], v[214:217], v[186:189]
  ds_read_b128 v[214:217], v33 offset:1664
  s_waitcnt lgkmcnt(7)
  v_mfma_f32_16x16x32_f16 v[182:185], v[130:133], v[218:221], v[182:185]
  v_mfma_f32_16x16x32_f16 v[186:189], v[146:149], v[218:221], v[186:189]
  ds_read_b128 v[218:221], v33 offset:1600
  v_mfma_f32_16x16x32_f16 v[190:193], v[230:233], v[170:173], v[190:193]
  s_waitcnt lgkmcnt(7)
  v_mfma_f32_16x16x32_f16 v[182:185], v[74:77], v[222:225], v[182:185]
  v_mfma_f32_16x16x32_f16 v[186:189], v[90:93], v[222:225], v[186:189]
  ds_read_b128 v[222:225], v33 offset:1536
  s_waitcnt lgkmcnt(7)
  v_mfma_f32_16x16x32_f16 v[182:185], v[10:13], v[194:197], v[182:185]
  v_mfma_f32_16x16x32_f16 v[186:189], v[118:121], v[194:197], v[186:189]
  v_mfma_f32_16x16x32_f16 v[190:193], v[166:169], v[194:197], v[190:193]
  ds_read_b128 v[194:197], v33 offset:2496
  s_waitcnt lgkmcnt(7)
  v_mfma_f32_16x16x32_f16 v[182:185], v[46:49], v[198:201], v[182:185]
  v_mfma_f32_16x16x32_f16 v[186:189], v[62:65], v[198:201], v[186:189]
  ds_read_b128 v[198:201], v33 offset:2432
  v_mfma_f32_16x16x32_f16 v[242:245], v[234:237], v[38:41], 0
  v_mfma_f32_16x16x32_f16 v[246:249], v[234:237], v[42:45], 0
  s_waitcnt lgkmcnt(7)
  v_mfma_f32_16x16x32_f16 v[182:185], v[14:17], v[202:205], v[182:185]
  v_mfma_f32_16x16x32_f16 v[186:189], v[122:125], v[202:205], v[186:189]
  ds_read_b128 v[202:205], v33 offset:2368
  s_waitcnt lgkmcnt(7)
  v_mfma_f32_16x16x32_f16 v[182:185], v[50:53], v[206:209], v[182:185]
  v_mfma_f32_16x16x32_f16 v[186:189], v[66:69], v[206:209], v[186:189]
  ds_read_b128 v[206:209], v33 offset:2304
  s_waitcnt lgkmcnt(7)
  v_mfma_f32_16x16x32_f16 v[182:185], v[110:113], v[210:213], v[182:185]
  v_mfma_f32_16x16x32_f16 v[186:189], v[126:129], v[210:213], v[186:189]
  ds_read_b128 v[210:213], v33 offset:2240
  v_cvt_pk_f16_f32 v234, v242, v246
  v_cvt_pk_f16_f32 v235, v243, v247
  v_cvt_pk_f16_f32 v236, v244, v248
  v_cvt_pk_f16_f32 v237, v245, v249
  s_waitcnt lgkmcnt(7)
  v_mfma_f32_16x16x32_f16 v[182:185], v[54:57], v[214:217], v[182:185]
  v_mfma_f32_16x16x32_f16 v[186:189], v[70:73], v[214:217], v[186:189]
  ds_read_b128 v[214:217], v33 offset:2176
  s_waitcnt lgkmcnt(7)
  v_mfma_f32_16x16x32_f16 v[182:185], v[114:117], v[218:221], v[182:185]
  v_mfma_f32_16x16x32_f16 v[186:189], v[130:133], v[218:221], v[186:189]
  ds_read_b128 v[218:221], v33 offset:2112
  v_mfma_f32_16x16x32_f16 v[190:193], v[234:237], v[28:31], v[190:193]
  s_waitcnt lgkmcnt(7)
  v_mfma_f32_16x16x32_f16 v[182:185], v[58:61], v[222:225], v[182:185]
  v_mfma_f32_16x16x32_f16 v[186:189], v[74:77], v[222:225], v[186:189]
  ds_read_b128 v[222:225], v33 offset:2048
  s_waitcnt lgkmcnt(7)
  v_mfma_f32_16x16x32_f16 v[186:189], v[10:13], v[194:197], v[186:189]
  v_mfma_f32_16x16x32_f16 v[190:193], v[150:153], v[194:197], v[190:193]
  ds_read_b128 v[194:197], v33 offset:3008
  s_waitcnt lgkmcnt(7)
  v_mfma_f32_16x16x32_f16 v[186:189], v[46:49], v[198:201], v[186:189]
  v_mfma_f32_16x16x32_f16 v[190:193], v[94:97], v[198:201], v[190:193]
  ds_read_b128 v[198:201], v33 offset:2944
  v_mfma_f32_16x16x32_f16 v[242:245], v[238:241], v[38:41], 0
  v_mfma_f32_16x16x32_f16 v[246:249], v[238:241], v[42:45], 0
  s_waitcnt lgkmcnt(7)
  v_mfma_f32_16x16x32_f16 v[186:189], v[14:17], v[202:205], v[186:189]
  v_mfma_f32_16x16x32_f16 v[190:193], v[154:157], v[202:205], v[190:193]
  ds_read_b128 v[202:205], v33 offset:2880
  ds_write_b128 v35, v[182:185] offset:12288
  s_mov_b64 exec, 1
  ds_add_u32 v36, v2 offset:48
  s_mov_b64 exec, -1
  s_waitcnt lgkmcnt(9)
  v_mfma_f32_16x16x32_f16 v[186:189], v[50:53], v[206:209], v[186:189]
  v_mfma_f32_16x16x32_f16 v[190:193], v[98:101], v[206:209], v[190:193]
  ds_read_b128 v[206:209], v33 offset:2816
  s_waitcnt lgkmcnt(9)
  v_mfma_f32_16x16x32_f16 v[186:189], v[110:113], v[210:213], v[186:189]
  v_mfma_f32_16x16x32_f16 v[190:193], v[158:161], v[210:213], v[190:193]
  ds_read_b128 v[210:213], v33 offset:2752
  v_cvt_pk_f16_f32 v238, v242, v246
  v_cvt_pk_f16_f32 v239, v243, v247
  v_cvt_pk_f16_f32 v240, v244, v248
  v_cvt_pk_f16_f32 v241, v245, v249
  s_waitcnt lgkmcnt(9)
  v_mfma_f32_16x16x32_f16 v[186:189], v[54:57], v[214:217], v[186:189]
  v_mfma_f32_16x16x32_f16 v[190:193], v[102:105], v[214:217], v[190:193]
  ds_read_b128 v[214:217], v33 offset:2688
  s_waitcnt lgkmcnt(9)
  v_mfma_f32_16x16x32_f16 v[186:189], v[114:117], v[218:221], v[186:189]
  v_mfma_f32_16x16x32_f16 v[190:193], v[162:165], v[218:221], v[190:193]
  ds_read_b128 v[218:221], v33 offset:2624
  v_mfma_f32_16x16x32_f16 v[190:193], v[238:241], v[18:21], v[190:193]
  s_waitcnt lgkmcnt(9)
  v_mfma_f32_16x16x32_f16 v[186:189], v[58:61], v[222:225], v[186:189]
  v_mfma_f32_16x16x32_f16 v[190:193], v[106:109], v[222:225], v[190:193]
  ds_read_b128 v[222:225], v33 offset:2560
  s_waitcnt lgkmcnt(9)
  v_mfma_f32_16x16x32_f16 v[190:193], v[134:137], v[194:197], v[190:193]
  ds_read_b128 v[194:197], v33 offset:3520
  s_waitcnt lgkmcnt(9)
  v_mfma_f32_16x16x32_f16 v[190:193], v[78:81], v[198:201], v[190:193]
  ds_read_b128 v[198:201], v33 offset:3456
  s_waitcnt lgkmcnt(9)
  v_mfma_f32_16x16x32_f16 v[190:193], v[138:141], v[202:205], v[190:193]
  ds_read_b128 v[202:205], v33 offset:3392
  ds_write_b128 v35, v[186:189] offset:16384
  s_mov_b64 exec, 1
  ds_add_u32 v36, v2 offset:64
  s_mov_b64 exec, -1
  s_waitcnt lgkmcnt(9)
  v_mfma_f32_16x16x32_f16 v[190:193], v[82:85], v[206:209], v[190:193]
  ds_read_b128 v[206:209], v33 offset:3328
  s_waitcnt lgkmcnt(9)
  v_mfma_f32_16x16x32_f16 v[190:193], v[142:145], v[210:213], v[190:193]
  ds_read_b128 v[210:213], v33 offset:3264
  s_waitcnt lgkmcnt(9)
  v_mfma_f32_16x16x32_f16 v[190:193], v[86:89], v[214:217], v[190:193]
  ds_read_b128 v[214:217], v33 offset:3200
  s_waitcnt lgkmcnt(9)
  v_mfma_f32_16x16x32_f16 v[190:193], v[146:149], v[218:221], v[190:193]
  ds_read_b128 v[218:221], v33 offset:3136
  s_waitcnt lgkmcnt(9)
  v_mfma_f32_16x16x32_f16 v[190:193], v[90:93], v[222:225], v[190:193]
  ds_read_b128 v[222:225], v33 offset:3072
  s_waitcnt lgkmcnt(9)
  v_mfma_f32_16x16x32_f16 v[190:193], v[118:121], v[194:197], v[190:193]
  ds_read_b128 v[194:197], v33 offset:4032
  s_waitcnt lgkmcnt(9)
  v_mfma_f32_16x16x32_f16 v[190:193], v[62:65], v[198:201], v[190:193]
  ds_read_b128 v[198:201], v33 offset:3968
  s_waitcnt lgkmcnt(9)
  v_mfma_f32_16x16x32_f16 v[190:193], v[122:125], v[202:205], v[190:193]
  ds_read_b128 v[202:205], v33 offset:3904
  s_waitcnt lgkmcnt(7)
  v_mfma_f32_16x16x32_f16 v[190:193], v[66:69], v[206:209], v[190:193]
  ds_read_b128 v[206:209], v33 offset:3840
  s_waitcnt lgkmcnt(7)
  v_mfma_f32_16x16x32_f16 v[190:193], v[126:129], v[210:213], v[190:193]
  ds_read_b128 v[210:213], v33 offset:3776
  s_waitcnt lgkmcnt(7)
  v_mfma_f32_16x16x32_f16 v[190:193], v[70:73], v[214:217], v[190:193]
  ds_read_b128 v[214:217], v33 offset:3712
  s_waitcnt lgkmcnt(7)
  v_mfma_f32_16x16x32_f16 v[190:193], v[130:133], v[218:221], v[190:193]
  ds_read_b128 v[218:221], v33 offset:3648
  s_waitcnt lgkmcnt(7)
  v_mfma_f32_16x16x32_f16 v[190:193], v[74:77], v[222:225], v[190:193]
  ds_read_b128 v[222:225], v33 offset:3584
  s_waitcnt lgkmcnt(7)
  v_mfma_f32_16x16x32_f16 v[190:193], v[10:13], v[194:197], v[190:193]
  s_waitcnt lgkmcnt(6)
  v_mfma_f32_16x16x32_f16 v[190:193], v[46:49], v[198:201], v[190:193]
  s_waitcnt lgkmcnt(5)
  v_mfma_f32_16x16x32_f16 v[190:193], v[14:17], v[202:205], v[190:193]
  s_waitcnt lgkmcnt(4)
  v_mfma_f32_16x16x32_f16 v[190:193], v[50:53], v[206:209], v[190:193]
  s_waitcnt lgkmcnt(3)
  v_mfma_f32_16x16x32_f16 v[190:193], v[110:113], v[210:213], v[190:193]
  s_waitcnt lgkmcnt(2)
  v_mfma_f32_16x16x32_f16 v[190:193], v[54:57], v[214:217], v[190:193]
  s_waitcnt lgkmcnt(1)
  v_mfma_f32_16x16x32_f16 v[190:193], v[114:117], v[218:221], v[190:193]
  s_waitcnt lgkmcnt(0)
  v_mfma_f32_16x16x32_f16 v[190:193], v[58:61], v[222:225], v[190:193]
  s_nop 7
  ds_write_b128 v35, v[190:193] offset:20480
  s_mov_b64 exec, 1
  ds_add_u32 v36, v2 offset:80
  s_mov_b64 exec, -1
  s_branch L_FIN
L_CONV1:
  ds_read_b128 v[194:197], v33 offset:448
  ds_read_b128 v[198:201], v33 offset:384
  ds_read_b128 v[202:205], v33 offset:320
  ds_read_b128 v[206:209], v33 offset:256
  ds_read_b128 v[210:213], v33 offset:192
  ds_read_b128 v[214:217], v33 offset:128
  ds_read_b128 v[218:221], v33 offset:64
  ds_read_b128 v[222:225], v33 offset:0
  v_mov_b32 v2, 1
  ds_read2_b64 v[226:229], v34 offset0:0 offset1:1
  ds_read2_b64 v[230:233], v34 offset0:64 offset1:65
  ds_read2_b64 v[234:237], v34 offset0:128 offset1:129
  s_waitcnt lgkmcnt(10)
  v_mfma_f32_16x16x32_f16 v[178:181], v[118:121], v[194:197], 0
  v_mfma_f32_16x16x32_f16 v[182:185], v[134:137], v[194:197], 0
  ds_read_b128 v[194:197], v33 offset:960
  s_waitcnt lgkmcnt(10)
  v_mfma_f32_16x16x32_f16 v[178:181], v[62:65], v[198:201], v[178:181]
  v_mfma_f32_16x16x32_f16 v[182:185], v[78:81], v[198:201], v[182:185]
  ds_read_b128 v[198:201], v33 offset:896
  s_waitcnt lgkmcnt(10)
  v_mfma_f32_16x16x32_f16 v[178:181], v[122:125], v[202:205], v[178:181]
  v_mfma_f32_16x16x32_f16 v[182:185], v[138:141], v[202:205], v[182:185]
  ds_read_b128 v[202:205], v33 offset:832
  s_waitcnt lgkmcnt(10)
  v_mfma_f32_16x16x32_f16 v[178:181], v[66:69], v[206:209], v[178:181]
  v_mfma_f32_16x16x32_f16 v[182:185], v[82:85], v[206:209], v[182:185]
  ds_read_b128 v[206:209], v33 offset:768
  s_waitcnt lgkmcnt(10)
  v_mfma_f32_16x16x32_f16 v[178:181], v[126:129], v[210:213], v[178:181]
  v_mfma_f32_16x16x32_f16 v[182:185], v[142:145], v[210:213], v[182:185]
  ds_read_b128 v[210:213], v33 offset:704
  s_waitcnt lgkmcnt(10)
  v_mfma_f32_16x16x32_f16 v[178:181], v[70:73], v[214:217], v[178:181]
  v_mfma_f32_16x16x32_f16 v[182:185], v[86:89], v[214:217], v[182:185]
  ds_read_b128 v[214:217], v33 offset:640
  s_waitcnt lgkmcnt(10)
  v_mfma_f32_16x16x32_f16 v[178:181], v[130:133], v[218:221], v[178:181]
  v_mfma_f32_16x16x32_f16 v[182:185], v[146:149], v[218:221], v[182:185]
  ds_read_b128 v[218:221], v33 offset:576
  s_waitcnt lgkmcnt(10)
  v_mfma_f32_16x16x32_f16 v[178:181], v[74:77], v[222:225], v[178:181]
  v_mfma_f32_16x16x32_f16 v[182:185], v[90:93], v[222:225], v[182:185]
  ds_read_b128 v[222:225], v33 offset:512
  s_waitcnt lgkmcnt(7)
  v_mfma_f32_16x16x32_f16 v[178:181], v[10:13], v[194:197], v[178:181]
  v_mfma_f32_16x16x32_f16 v[182:185], v[118:121], v[194:197], v[182:185]
  v_mfma_f32_16x16x32_f16 v[186:189], v[166:169], v[194:197], 0
  ds_read_b128 v[194:197], v33 offset:1472
  s_waitcnt lgkmcnt(7)
  v_mfma_f32_16x16x32_f16 v[178:181], v[46:49], v[198:201], v[178:181]
  v_mfma_f32_16x16x32_f16 v[182:185], v[62:65], v[198:201], v[182:185]
  ds_read_b128 v[198:201], v33 offset:1408
  v_mfma_f32_16x16x32_f16 v[238:241], v[226:229], v[38:41], 0
  v_mfma_f32_16x16x32_f16 v[242:245], v[226:229], v[42:45], 0
  s_waitcnt lgkmcnt(7)
  v_mfma_f32_16x16x32_f16 v[178:181], v[14:17], v[202:205], v[178:181]
  v_mfma_f32_16x16x32_f16 v[182:185], v[122:125], v[202:205], v[182:185]
  ds_read_b128 v[202:205], v33 offset:1344
  s_waitcnt lgkmcnt(7)
  v_mfma_f32_16x16x32_f16 v[178:181], v[50:53], v[206:209], v[178:181]
  v_mfma_f32_16x16x32_f16 v[182:185], v[66:69], v[206:209], v[182:185]
  ds_read_b128 v[206:209], v33 offset:1280
  s_waitcnt lgkmcnt(7)
  v_mfma_f32_16x16x32_f16 v[178:181], v[110:113], v[210:213], v[178:181]
  v_mfma_f32_16x16x32_f16 v[182:185], v[126:129], v[210:213], v[182:185]
  ds_read_b128 v[210:213], v33 offset:1216
  v_cvt_pk_f16_f32 v226, v238, v242
  v_cvt_pk_f16_f32 v227, v239, v243
  v_cvt_pk_f16_f32 v228, v240, v244
  v_cvt_pk_f16_f32 v229, v241, v245
  s_waitcnt lgkmcnt(7)
  v_mfma_f32_16x16x32_f16 v[178:181], v[54:57], v[214:217], v[178:181]
  v_mfma_f32_16x16x32_f16 v[182:185], v[70:73], v[214:217], v[182:185]
  ds_read_b128 v[214:217], v33 offset:1152
  s_waitcnt lgkmcnt(7)
  v_mfma_f32_16x16x32_f16 v[178:181], v[114:117], v[218:221], v[178:181]
  v_mfma_f32_16x16x32_f16 v[182:185], v[130:133], v[218:221], v[182:185]
  ds_read_b128 v[218:221], v33 offset:1088
  v_mfma_f32_16x16x32_f16 v[186:189], v[226:229], v[28:31], v[186:189]
  v_mfma_f32_16x16x32_f16 v[190:193], v[226:229], v[170:173], 0
  s_waitcnt lgkmcnt(7)
  v_mfma_f32_16x16x32_f16 v[178:181], v[58:61], v[222:225], v[178:181]
  v_mfma_f32_16x16x32_f16 v[182:185], v[74:77], v[222:225], v[182:185]
  ds_read_b128 v[222:225], v33 offset:1024
  s_waitcnt lgkmcnt(7)
  v_mfma_f32_16x16x32_f16 v[182:185], v[10:13], v[194:197], v[182:185]
  v_mfma_f32_16x16x32_f16 v[186:189], v[150:153], v[194:197], v[186:189]
  v_mfma_f32_16x16x32_f16 v[190:193], v[166:169], v[194:197], v[190:193]
  ds_read_b128 v[194:197], v33 offset:1984
  s_waitcnt lgkmcnt(7)
  v_mfma_f32_16x16x32_f16 v[182:185], v[46:49], v[198:201], v[182:185]
  v_mfma_f32_16x16x32_f16 v[186:189], v[94:97], v[198:201], v[186:189]
  ds_read_b128 v[198:201], v33 offset:1920
  v_mfma_f32_16x16x32_f16 v[238:241], v[230:233], v[38:41], 0
  v_mfma_f32_16x16x32_f16 v[242:245], v[230:233], v[42:45], 0
  s_waitcnt lgkmcnt(7)
  v_mfma_f32_16x16x32_f16 v[182:185], v[14:17], v[202:205], v[182:185]
  v_mfma_f32_16x16x32_f16 v[186:189], v[154:157], v[202:205], v[186:189]
  ds_read_b128 v[202:205], v33 offset:1856
  ds_write_b128 v35, v[178:181] offset:8192
  s_mov_b64 exec, 1
  ds_add_u32 v36, v2 offset:32
  s_mov_b64 exec, -1
  s_waitcnt lgkmcnt(9)
  v_mfma_f32_16x16x32_f16 v[182:185], v[50:53], v[206:209], v[182:185]
  v_mfma_f32_16x16x32_f16 v[186:189], v[98:101], v[206:209], v[186:189]
  ds_read_b128 v[206:209], v33 offset:1792
  s_waitcnt lgkmcnt(9)
  v_mfma_f32_16x16x32_f16 v[182:185], v[110:113], v[210:213], v[182:185]
  v_mfma_f32_16x16x32_f16 v[186:189], v[158:161], v[210:213], v[186:189]
  ds_read_b128 v[210:213], v33 offset:1728
  v_cvt_pk_f16_f32 v230, v238, v242
  v_cvt_pk_f16_f32 v231, v239, v243
  v_cvt_pk_f16_f32 v232, v240, v244
  v_cvt_pk_f16_f32 v233, v241, v245
  s_waitcnt lgkmcnt(9)
  v_mfma_f32_16x16x32_f16 v[182:185], v[54:57], v[214:217], v[182:185]
  v_mfma_f32_16x16x32_f16 v[186:189], v[102:105], v[214:217], v[186:189]
  ds_read_b128 v[214:217], v33 offset:1664
  s_waitcnt lgkmcnt(9)
  v_mfma_f32_16x16x32_f16 v[182:185], v[114:117], v[218:221], v[182:185]
  v_mfma_f32_16x16x32_f16 v[186:189], v[162:165], v[218:221], v[186:189]
  ds_read_b128 v[218:221], v33 offset:1600
  v_mfma_f32_16x16x32_f16 v[186:189], v[230:233], v[18:21], v[186:189]
  v_mfma_f32_16x16x32_f16 v[190:193], v[230:233], v[28:31], v[190:193]
  s_waitcnt lgkmcnt(9)
  v_mfma_f32_16x16x32_f16 v[182:185], v[58:61], v[222:225], v[182:185]
  v_mfma_f32_16x16x32_f16 v[186:189], v[106:109], v[222:225], v[186:189]
  ds_read_b128 v[222:225], v33 offset:1536
  s_waitcnt lgkmcnt(9)
  v_mfma_f32_16x16x32_f16 v[186:189], v[134:137], v[194:197], v[186:189]
  v_mfma_f32_16x16x32_f16 v[190:193], v[150:153], v[194:197], v[190:193]
  ds_read_b128 v[194:197], v33 offset:2496
  s_waitcnt lgkmcnt(9)
  v_mfma_f32_16x16x32_f16 v[186:189], v[78:81], v[198:201], v[186:189]
  v_mfma_f32_16x16x32_f16 v[190:193], v[94:97], v[198:201], v[190:193]
  ds_read_b128 v[198:201], v33 offset:2432
  v_mfma_f32_16x16x32_f16 v[238:241], v[234:237], v[38:41], 0
  v_mfma_f32_16x16x32_f16 v[242:245], v[234:237], v[42:45], 0
  s_waitcnt lgkmcnt(9)
  v_mfma_f32_16x16x32_f16 v[186:189], v[138:141], v[202:205], v[186:189]
  v_mfma_f32_16x16x32_f16 v[190:193], v[154:157], v[202:205], v[190:193]
  ds_read_b128 v[202:205], v33 offset:2368
  ds_write_b128 v35, v[182:185] offset:12288
  s_mov_b64 exec, 1
  ds_add_u32 v36, v2 offset:48
  s_mov_b64 exec, -1
  s_waitcnt lgkmcnt(9)
  v_mfma_f32_16x16x32_f16 v[186:189], v[82:85], v[206:209], v[186:189]
  v_mfma_f32_16x16x32_f16 v[190:193], v[98:101], v[206:209], v[190:193]
  ds_read_b128 v[206:209], v33 offset:2304
  s_waitcnt lgkmcnt(9)
  v_mfma_f32_16x16x32_f16 v[186:189], v[142:145], v[210:213], v[186:189]
  v_mfma_f32_16x16x32_f16 v[190:193], v[158:161], v[210:213], v[190:193]
  ds_read_b128 v[210:213], v33 offset:2240
  v_cvt_pk_f16_f32 v234, v238, v242
  v_cvt_pk_f16_f32 v235, v239, v243
  v_cvt_pk_f16_f32 v236, v240, v244
  v_cvt_pk_f16_f32 v237, v241, v245
  s_waitcnt lgkmcnt(9)
  v_mfma_f32_16x16x32_f16 v[186:189], v[86:89], v[214:217], v[186:189]
  v_mfma_f32_16x16x32_f16 v[190:193], v[102:105], v[214:217], v[190:193]
  ds_read_b128 v[214:217], v33 offset:2176
  s_waitcnt lgkmcnt(9)
  v_mfma_f32_16x16x32_f16 v[186:189], v[146:149], v[218:221], v[186:189]
  v_mfma_f32_16x16x32_f16 v[190:193], v[162:165], v[218:221], v[190:193]
  ds_read_b128 v[218:221], v33 offset:2112
  v_mfma_f32_16x16x32_f16 v[190:193], v[234:237], v[18:21], v[190:193]
  s_waitcnt lgkmcnt(9)
  v_mfma_f32_16x16x32_f16 v[186:189], v[90:93], v[222:225], v[186:189]
  v_mfma_f32_16x16x32_f16 v[190:193], v[106:109], v[222:225], v[190:193]
  ds_read_b128 v[222:225], v33 offset:2048
  s_waitcnt lgkmcnt(9)
  v_mfma_f32_16x16x32_f16 v[186:189], v[118:121], v[194:197], v[186:189]
  v_mfma_f32_16x16x32_f16 v[190:193], v[134:137], v[194:197], v[190:193]
  ds_read_b128 v[194:197], v33 offset:3008
  s_waitcnt lgkmcnt(9)
  v_mfma_f32_16x16x32_f16 v[186:189], v[62:65], v[198:201], v[186:189]
  v_mfma_f32_16x16x32_f16 v[190:193], v[78:81], v[198:201], v[190:193]
  ds_read_b128 v[198:201], v33 offset:2944
  s_waitcnt lgkmcnt(9)
  v_mfma_f32_16x16x32_f16 v[186:189], v[122:125], v[202:205], v[186:189]
  v_mfma_f32_16x16x32_f16 v[190:193], v[138:141], v[202:205], v[190:193]
  ds_read_b128 v[202:205], v33 offset:2880
  s_waitcnt lgkmcnt(7)
  v_mfma_f32_16x16x32_f16 v[186:189], v[66:69], v[206:209], v[186:189]
  v_mfma_f32_16x16x32_f16 v[190:193], v[82:85], v[206:209], v[190:193]
  ds_read_b128 v[206:209], v33 offset:2816
  s_waitcnt lgkmcnt(7)
  v_mfma_f32_16x16x32_f16 v[186:189], v[126:129], v[210:213], v[186:189]
  v_mfma_f32_16x16x32_f16 v[190:193], v[142:145], v[210:213], v[190:193]
  ds_read_b128 v[210:213], v33 offset:2752
  s_waitcnt lgkmcnt(7)
  v_mfma_f32_16x16x32_f16 v[186:189], v[70:73], v[214:217], v[186:189]
  v_mfma_f32_16x16x32_f16 v[190:193], v[86:89], v[214:217], v[190:193]
  ds_read_b128 v[214:217], v33 offset:2688
  s_waitcnt lgkmcnt(7)
  v_mfma_f32_16x16x32_f16 v[186:189], v[130:133], v[218:221], v[186:189]
  v_mfma_f32_16x16x32_f16 v[190:193], v[146:149], v[218:221], v[190:193]
  ds_read_b128 v[218:221], v33 offset:2624
  s_waitcnt lgkmcnt(7)
  v_mfma_f32_16x16x32_f16 v[186:189], v[74:77], v[222:225], v[186:189]
  v_mfma_f32_16x16x32_f16 v[190:193], v[90:93], v[222:225], v[190:193]
  ds_read_b128 v[222:225], v33 offset:2560
  s_waitcnt lgkmcnt(7)
  v_mfma_f32_16x16x32_f16 v[186:189], v[10:13], v[194:197], v[186:189]
  v_mfma_f32_16x16x32_f16 v[190:193], v[118:121], v[194:197], v[190:193]
  ds_read_b128 v[194:197], v33 offset:3520
  s_waitcnt lgkmcnt(7)
  v_mfma_f32_16x16x32_f16 v[186:189], v[46:49], v[198:201], v[186:189]
  v_mfma_f32_16x16x32_f16 v[190:193], v[62:65], v[198:201], v[190:193]
  ds_read_b128 v[198:201], v33 offset:3456
  s_waitcnt lgkmcnt(7)
  v_mfma_f32_16x16x32_f16 v[186:189], v[14:17], v[202:205], v[186:189]
  v_mfma_f32_16x16x32_f16 v[190:193], v[122:125], v[202:205], v[190:193]
  ds_read_b128 v[202:205], v33 offset:3392
  s_waitcnt lgkmcnt(7)
  v_mfma_f32_16x16x32_f16 v[186:189], v[50:53], v[206:209], v[186:189]
  v_mfma_f32_16x16x32_f16 v[190:193], v[66:69], v[206:209], v[190:193]
  ds_read_b128 v[206:209], v33 offset:3328
  s_waitcnt lgkmcnt(7)
  v_mfma_f32_16x16x32_f16 v[186:189], v[110:113], v[210:213], v[186:189]
  v_mfma_f32_16x16x32_f16 v[190:193], v[126:129], v[210:213], v[190:193]
  ds_read_b128 v[210:213], v33 offset:3264
  s_waitcnt lgkmcnt(7)
  v_mfma_f32_16x16x32_f16 v[186:189], v[54:57], v[214:217], v[186:189]
  v_mfma_f32_16x16x32_f16 v[190:193], v[70:73], v[214:217], v[190:193]
  ds_read_b128 v[214:217], v33 offset:3200
  s_waitcnt lgkmcnt(7)
  v_mfma_f32_16x16x32_f16 v[186:189], v[114:117], v[218:221], v[186:189]
  v_mfma_f32_16x16x32_f16 v[190:193], v[130:133], v[218:221], v[190:193]
  ds_read_b128 v[218:221], v33 offset:3136
  s_waitcnt lgkmcnt(7)
  v_mfma_f32_16x16x32_f16 v[186:189], v[58:61], v[222:225], v[186:189]
  v_mfma_f32_16x16x32_f16 v[190:193], v[74:77], v[222:225], v[190:193]
  ds_read_b128 v[222:225], v33 offset:3072
  s_waitcnt lgkmcnt(7)
  v_mfma_f32_16x16x32_f16 v[190:193], v[10:13], v[194:197], v[190:193]
  s_waitcnt lgkmcnt(6)
  v_mfma_f32_16x16x32_f16 v[190:193], v[46:49], v[198:201], v[190:193]
  s_waitcnt lgkmcnt(5)
  v_mfma_f32_16x16x32_f16 v[190:193], v[14:17], v[202:205], v[190:193]
  ds_write_b128 v35, v[186:189] offset:16384
  s_mov_b64 exec, 1
  ds_add_u32 v36, v2 offset:64
  s_mov_b64 exec, -1
  s_waitcnt lgkmcnt(6)
  v_mfma_f32_16x16x32_f16 v[190:193], v[50:53], v[206:209], v[190:193]
  s_waitcnt lgkmcnt(5)
  v_mfma_f32_16x16x32_f16 v[190:193], v[110:113], v[210:213], v[190:193]
  s_waitcnt lgkmcnt(4)
  v_mfma_f32_16x16x32_f16 v[190:193], v[54:57], v[214:217], v[190:193]
  s_waitcnt lgkmcnt(3)
  v_mfma_f32_16x16x32_f16 v[190:193], v[114:117], v[218:221], v[190:193]
  s_waitcnt lgkmcnt(2)
  v_mfma_f32_16x16x32_f16 v[190:193], v[58:61], v[222:225], v[190:193]
  s_nop 7
  ds_write_b128 v35, v[190:193] offset:20480
  s_mov_b64 exec, 1
  ds_add_u32 v36, v2 offset:80
  s_mov_b64 exec, -1
L_FIN:
L_EXIT:
  s_endpgm
L_END:
.section .rodata,"a"
.p2align 6
.amdhsa_kernel recurrent_scan__ssm_conv_s4d__moe_arch_mod__prompt_kernel
  .amdhsa_next_free_vgpr 252
  .amdhsa_next_free_sgpr 102
  .amdhsa_accum_offset 252
  .amdhsa_group_segment_fixed_size 0
  .amdhsa_kernarg_size 120
  .amdhsa_user_sgpr_count 2
  .amdhsa_user_sgpr_kernarg_segment_ptr 1
  .amdhsa_system_sgpr_workgroup_id_x 1
.end_amdhsa_kernel
```
